```python
import torch

def _softmax(x, axis=-1):
    return torch.softmax(x, dim=axis)
def _gelu(x):
    return torch.nn.functional.gelu(x, approximate="tanh")
def _silu(x):
    return torch.nn.functional.silu(x)
def _sigmoid(x):
    return torch.sigmoid(x)
def _layernorm(x, axis=-1, eps=1e-5):
    m = x.mean(dim=axis, keepdim=True)
    v = x.var(dim=axis, keepdim=True, unbiased=False)
    return (x - m) / torch.sqrt(v + eps)
def _scatter_add(tgt, idx, src, axis=0):
    return tgt.clone().index_add_(axis, idx, src)
def _segment_sum(src, seg, n):
    out = torch.zeros((n,) + src.shape[1:], dtype=src.dtype)
    return out.index_add_(0, seg, src)
def _pad(x, pw):
    flat = tuple(v for pair in reversed(pw) for v in pair)
    return torch.nn.functional.pad(x, flat)

kernel_name = 'recurrent_scan__ssm_conv_s4d__mixer_s_mlp__prompt'

def setup_inputs():

    _w = (lambda a: (lambda t: t.to(torch.bfloat16) if t.is_floating_point() else t)(torch.as_tensor(a)))
    def _A_setup():
        Bsz, L, D, N = 1, 2048, 512, 128
        return {
            "u": _w((lambda *s: torch.randn(*s, dtype=torch.bfloat16) * 0.05)(Bsz, L, D)),
            "log_A_real": _w((lambda *s: torch.randn(*s, dtype=torch.bfloat16) * 6.4)(D, N) * 0.5),
            "A_imag": _w((lambda *s: torch.randn(*s, dtype=torch.bfloat16) * 0.05)(D, N) * 3.14),
            "C_real": _w((lambda *s: torch.randn(*s, dtype=torch.bfloat16) * 0.05)(D, N) / N ** 0.5),
            "C_imag": _w((lambda *s: torch.randn(*s, dtype=torch.bfloat16) * 0.05)(D, N) / N ** 0.5),
            "log_dt": _w((lambda *s: torch.randn(*s, dtype=torch.bfloat16) * 0.05)(D) * 0.5 - 4.0),
            "D_skip": _w((lambda *s: torch.randn(*s, dtype=torch.bfloat16) * 0.05)(D)),
        }
    _A_in = _A_setup()

    def _B_setup():
        B, S, D, F = 1, 2048, 512, 1792
        return {
            "x":  _w((lambda *s: torch.randn(*s, dtype=torch.bfloat16) * 0.05)(B, S, D)),
            "w1": _w((lambda *s: torch.randn(*s, dtype=torch.bfloat16) * 6.4)(D, D) * (D ** -0.5)),
            "w2": _w((lambda *s: torch.randn(*s, dtype=torch.bfloat16) * 6.4)(D, D) * (D ** -0.5)),
            "w3": _w((lambda *s: torch.randn(*s, dtype=torch.bfloat16) * 6.4)(D, F) * (D ** -0.5)),
            "w4": _w((lambda *s: torch.randn(*s, dtype=torch.bfloat16) * 6.4)(F, D) * (F ** -0.5)),
        }
    _B_in = _B_setup()

    return {
        "A_u": _A_in["u"],
        "A_log_A_real": _A_in["log_A_real"],
        "A_A_imag": _A_in["A_imag"],
        "A_C_real": _A_in["C_real"],
        "A_C_imag": _A_in["C_imag"],
        "A_log_dt": _A_in["log_dt"],
        "A_D_skip": _A_in["D_skip"],
        "B_x": _B_in["x"],
        "B_w1": _B_in["w1"],
        "B_w2": _B_in["w2"],
        "B_w3": _B_in["w3"],
        "B_w4": _B_in["w4"],
    }

def reference(A_u, A_log_A_real, A_A_imag, A_C_real, A_C_imag, A_log_dt, A_D_skip, B_x, B_w1, B_w2, B_w3, B_w4):
    def _A_ref(u, log_A_real, A_imag, C_real, C_imag, log_dt, D_skip):
        L = u.shape[1]
        dt = torch.exp(log_dt)
        A = -torch.exp(log_A_real) + 1j * A_imag
        C = (C_real + 1j * C_imag) * dt[:, None]
        pos = (lambda x, dt: x.to(dt))(torch.arange(L), log_dt.dtype)
        P = torch.exp((A * dt[:, None])[:, :, None] * pos[None, None, :])
        K = 2.0 * torch.einsum("dn,dnl->dl", C, P).real
        L2 = 2 * L
        u_t = (lambda x, *d: x.permute(*d))(u, 0, 2, 1)
        Kf = (lambda x, *a, **k: torch.fft.rfft(x.float(), *a, **k))(K, L2)
        Uf = (lambda x, *a, **k: torch.fft.rfft(x.float(), *a, **k))(u_t, L2)
        y = (lambda x, *a, **k: torch.fft.irfft(x, *a, **k).to(torch.bfloat16))(Uf * Kf[None, :, :], L2)[:, :, :L]
        y = (lambda x, *d: x.permute(*d))(y, 0, 2, 1)
        return y + u * D_skip[None, None, :]

    def _B_ref(x, w1, w2, w3, w4):
        B, S, D = x.shape
        h = _gelu(_layernorm(x, axis=-1) @ w1)
        c = D // 4
        g0 = _pad(h[:, :, 0*c:1*c], ((0, 0), (1, 0), (0, 0)))[:, :S, :]
        g1 = _pad(h[:, :, 1*c:2*c], ((0, 0), (0, 1), (0, 0)))[:, 1:, :]
        g2 = _pad(h[:, :, 2*c:3*c], ((0, 0), (2, 0), (0, 0)))[:, :S, :]
        g3 = _pad(h[:, :, 3*c:   ], ((0, 0), (0, 2), (0, 0)))[:, 2:, :]
        hs = torch.concatenate([g0, g1, g2, g3], axis=-1) @ w2
        x1 = x + hs
        h2 = _gelu(_layernorm(x1, axis=-1) @ w3) @ w4
        return x1 + h2

    x = A_u
    xn = _layernorm(x, axis=-1)
    s = _A_ref(xn, A_log_A_real, A_A_imag, A_C_real, A_C_imag, A_log_dt, A_D_skip)
    g = _silu(_B_ref(xn, B_w1, B_w2, B_w3, B_w4))
    return x + s * g
```

```asm
; @launch grid=(256,1,1) block=(256,1,1) lds=163840
.amdgcn_target "amdgcn-amd-amdhsa--gfx950"
.text
.globl recurrent_scan__ssm_conv_s4d__mixer_s_mlp__prompt_kernel
.p2align 8
.type recurrent_scan__ssm_conv_s4d__mixer_s_mlp__prompt_kernel,@function
recurrent_scan__ssm_conv_s4d__mixer_s_mlp__prompt_kernel:
KSTART:
  s_cmp_ge_u32 s2, 0x100
  s_cbranch_scc1 END
  s_load_dwordx16 s[4:19], s[0:1], 0
  s_load_dwordx8 s[20:27], s[0:1], 64
  s_load_dwordx4 s[28:31], s[0:1], 96
  s_load_dwordx2 s[32:33], s[0:1], 112
  v_lshrrev_b32 v4, 6, v0
  v_and_b32 v255, 63, v0
  s_lshr_b32 s44, s2, 3
  v_readfirstlane_b32 s41, v4
  s_getpc_b64 s[36:37]
PCREF:
  s_lshl_b32 s34, s44, 3
  s_lshl_b32 s35, s41, 1
  s_add_u32 s34, s34, s35
  v_add_u32 v5, s34, v255
  v_lshlrev_b32 v5, 7, v5
  v_min_u32 v5, END-PCREF, v5
  s_mov_b64 exec, 3
  global_load_dword v254, v5, s[36:37]
  s_mov_b64 exec, -1
  s_and_b32 s34, s2, 7
  s_lshr_b32 s35, s2, 6
  s_lshl_b32 s38, s34, 2
  s_add_u32 s3, s38, s35
  s_and_b32 s40, s44, 7
  s_and_b32 s42, s41, 1
  s_lshr_b32 s43, s41, 1
  s_bfe_u32 s47, s40, 0x10001
  s_lshr_b32 s48, s40, 2
  s_add_u32 s48, s48, 1
  s_sub_u32 s35, 2, s48
  s_cmp_eq_u32 s47, 1
  s_cselect_b32 s45, s48, s35
  s_cselect_b32 s46, 0, 2
  s_lshl_b32 s49, s3, 6
  s_sub_u32 s49, s49, s46
  s_lshl_b32 s35, s44, 2
  s_add_u32 s35, s35, s41
  s_lshl_b32 s38, s35, 12
  v_lshl_add_u32 v1, v255, 7, s38
  s_lshl_b32 s34, s34, 18
  s_lshl_b32 s35, s35, 11
  s_add_u32 s34, s34, s35
  v_lshl_add_u32 v2, v255, 7, s34
  s_lshl_b32 s50, s40, 6
  s_lshl_b32 s34, s3, 1
  s_add_u32 s50, s50, s34
  s_add_u32 s50, s50, s43
  s_lshl_b32 s34, s50, 8
  s_lshl_b32 s35, s42, 7
  s_add_u32 s34, s34, s35
  s_lshl_b32 s35, s50, 1
  v_lshl_add_u32 v10, v255, 1, s34
  v_mov_b32 v11, s35
  v_lshrrev_b32 v4, 4, v255
  v_and_b32 v5, 15, v255
  v_xor_b32 v5, v5, v4
  v_lshlrev_b32 v5, 4, v5
  s_lshl_b32 s34, s41, 4
  s_add_u32 s34, s34, s49
  v_add_u32 v6, s34, v4
  v_lshlrev_b32 v6, 10, v6
  v_add_u32 v12, v6, v5
  v_xor_b32 v7, 64, v5
  v_add_u32 v7, 3072, v7
  v_add_u32 v13, v6, v7
  v_xor_b32 v7, 128, v5
  v_add_u32 v7, 6144, v7
  v_add_u32 v14, v6, v7
  v_xor_b32 v7, 192, v5
  v_add_u32 v7, 9216, v7
  v_add_u32 v15, v6, v7
  s_add_u32 s34, s49, 64
  v_add_u32 v6, s34, v4
  v_lshlrev_b32 v6, 10, v6
  s_lshl_b32 s34, s41, 8
  v_add3_u32 v3, v6, v5, s34
  v_mov_b32 v9, 0x80000000
  s_mul_i32 s34, s41, 16896
  s_add_u32 m0, s34, 16384
  s_lshl_b32 s51, s41, 12
  s_waitcnt lgkmcnt(0)
  global_load_ushort v246, v10, s[6:7]
  global_load_ushort v247, v10, s[8:9]
  global_load_ushort v248, v10, s[10:11]
  global_load_ushort v249, v10, s[12:13]
  global_load_ushort v250, v11, s[14:15]
  global_load_ushort v251, v11, s[16:17]
  v_xor_b32 v10, 0x80, v10
  global_load_ushort v252, v10, s[10:11]
  global_load_ushort v253, v10, s[12:13]
  s_mov_b32 s52, s4
  s_mov_b32 s53, s5
  s_mov_b32 s54, 0x200000
  s_mov_b32 s55, 0x20000
  s_mov_b32 s56, s20
  s_mov_b32 s57, s21
  s_mov_b32 s58, 0x80000
  s_mov_b32 s59, 0x20000
  s_mov_b32 exec_lo, 0xffff
  s_mov_b32 exec_hi, 0
  buffer_load_dword v254, v2, s[52:55], 0 offen
  s_mov_b32 exec_lo, -1
  buffer_load_dword v254, v1, s[56:59], 0 offen
  buffer_load_dwordx4 v3, s[52:55], 0 offen lds
  s_mov_b32 exec_hi, -1
  s_add_u32 m0, s51, 0
  s_nop 0
  buffer_load_dwordx4 v12, s[52:55], 0 offen offset:0 lds
  buffer_load_dwordx4 v13, s[52:55], 0 offen offset:1024 lds
  buffer_load_dwordx4 v14, s[52:55], 0 offen offset:2048 lds
  buffer_load_dwordx4 v15, s[52:55], 0 offen offset:3072 lds
  s_add_u32 m0, s51, 16640
  s_nop 0
  buffer_load_dwordx4 v12, s[52:55], 0 offen offset:256 lds
  buffer_load_dwordx4 v13, s[52:55], 0 offen offset:1280 lds
  buffer_load_dwordx4 v14, s[52:55], 0 offen offset:2304 lds
  buffer_load_dwordx4 v15, s[52:55], 0 offen offset:3328 lds
  s_mov_b32 s4, s22
  s_mov_b32 s5, s23
  s_mov_b32 s6, 0x80000
  s_mov_b32 s7, 0x20000
  s_mov_b32 s8, s24
  s_mov_b32 s9, s25
  s_mov_b32 s10, 0x1c0000
  s_mov_b32 s11, 0x20000
  s_mov_b32 s12, s26
  s_mov_b32 s13, s27
  s_mov_b32 s14, 0x1c0000
  s_mov_b32 s15, 0x20000
  s_mov_b32 s16, s28
  s_mov_b32 s17, s29
  s_mov_b32 s18, 0x200000
  s_mov_b32 s19, 0x20000
  s_mov_b32 s60, s32
  s_mov_b32 s61, s33
  s_mov_b32 s62, 0x1600000
  s_mov_b32 s63, 0x20000
  v_cmp_eq_u32 vcc, 0, v0
  v_mov_b32 v4, 0
  s_or_b32 s34, s2, s41
  v_cndmask_b32 v243, v9, v4, vcc
  s_cmp_lg_u32 s34, 0
  s_cbranch_scc1 NN_1
  s_memrealtime s[20:21]
  s_waitcnt lgkmcnt(0)
  s_or_b32 s20, s20, 1
  v_mov_b32 v244, s20
  v_mov_b32 v245, s21
  s_mov_b64 exec, 1
  global_store_dwordx2 v4, v[244:245], s[30:31] sc1
  s_mov_b64 exec, -1
NN_1:
  v_lshrrev_b32 v7, 3, v255
  v_and_b32 v8, 7, v255
  v_bfe_u32 v6, v255, 4, 1
  v_lshlrev_b32 v6, 2, v6
  v_xor_b32 v8, v8, v6
  v_lshlrev_b32 v8, 4, v8
  v_lshl_add_u32 v236, v7, 10, v8
  v_mul_u32_u24 v7, 3584, v7
  v_add_u32 v232, v7, v8
  s_cmp_eq_u32 s41, 3
  s_cselect_b32 s36, 64, 128
  v_cmp_le_u32 vcc, s36, v8
  s_lshl_b32 s22, s41, 15
  s_lshl_b32 s34, s40, 7
  s_add_u32 s22, s22, s34
  v_cndmask_b32 v232, v232, v9, vcc
  v_add_u32 v237, 7168, v236
  v_add_u32 v233, 27648, v232
  v_add_u32 v238, 14336, v236
  v_add_u32 v234, 55296, v232
  v_add_u32 v239, 21504, v236
  v_add_u32 v235, 82944, v232
  s_lshl_b32 s34, s44, 2
  s_add_u32 s34, s34, s41
  s_lshl_b32 s34, s34, 15
  s_and_b32 s35, s2, 7
  s_xor_b32 s35, s35, 0
  s_lshl_b32 s35, s35, 7
  s_add_u32 s34, s34, s35
  v_lshl_add_u32 v240, v255, 10, s34
  v_cmp_lt_u32 vcc, 31, v255
  s_nop 1
  v_cndmask_b32 v240, v240, v9, vcc
  v_subrev_u32 v241, 524288, v240
  v_subrev_u32 v242, 2359296, v240
  v_and_b32 v229, 31, v255
  v_lshrrev_b32 v230, 5, v255
  s_lshl_b32 s34, s43, 5
  s_add_u32 s35, s34, s45
  v_add_u32 v4, s35, v229
  v_and_b32 v5, 15, v4
  v_xor_b32 v5, v5, v230
  s_lshl_b32 s36, s42, 1
  v_xor_b32 v5, s36, v5
  v_lshlrev_b32 v5, 4, v5
  v_lshl_add_u32 v16, v4, 8, v5
  v_xor_b32 v17, 32, v16
  v_xor_b32 v18, 64, v16
  v_xor_b32 v19, 96, v16
  v_xor_b32 v20, 128, v16
  v_xor_b32 v21, 160, v16
  v_xor_b32 v22, 192, v16
  v_xor_b32 v23, 224, v16
  v_lshlrev_b32 v27, 5, v4
  v_add_u32 v27, 145344, v27
  v_add_u32 v6, s36, v230
  v_lshl_add_u32 v26, v6, 3, v27
  s_add_u32 s35, s34, s46
  v_add_u32 v4, s35, v229
  v_lshlrev_b32 v28, 5, v4
  v_add_u32 v28, 145344, v28
  s_and_b32 s35, s40, 1
  s_lshl_b32 s35, s35, 3
  s_lshl_b32 s37, s42, 2
  s_add_u32 s35, s35, s37
  v_and_b32 v5, 15, v4
  v_xor_b32 v5, s35, v5
  v_lshlrev_b32 v5, 4, v5
  v_lshl_add_u32 v5, v4, 8, v5
  v_lshl_add_u32 v5, v230, 3, v5
  s_lshr_b32 s35, s40, 1
  s_mul_i32 s35, s35, 16896
  v_add_u32 v32, s35, v5
  v_xor_b32 v33, 16, v32
  v_xor_b32 v34, 32, v32
  v_xor_b32 v35, 48, v32
  v_bfe_u32 v4, v255, 2, 2
  v_and_b32 v5, 3, v255
  v_bfe_u32 v6, v255, 4, 1
  v_lshlrev_b32 v5, 3, v5
  v_lshl_add_u32 v5, v6, 5, v5
  s_mul_i32 s34, s41, 2544
  s_add_u32 s34, s34, 135168
  v_lshl_add_u32 v7, v230, 3, v4
  v_mul_u32_u24 v7, 72, v7
  v_add3_u32 v30, v7, v5, s34
  v_mul_u32_u24 v7, 72, v229
  v_lshl_add_u32 v7, v230, 3, v7
  v_add_u32 v29, s34, v7
  v_mul_u32_u24 v7, 80, v229
  v_lshl_add_u32 v7, v230, 4, v7
  v_add_u32 v31, s34, v7
  v_lshrrev_b32 v6, 1, v4
  v_lshl_add_u32 v5, v6, 6, v5
  v_lshl_add_u32 v5, v4, 7, v5
  v_lshl_add_u32 v231, v230, 9, v5
  v_lshl_add_u32 v5, v230, 10, v5
  s_lshl_b32 s35, s42, 6
  v_xor_b32 v5, s35, v5
  s_lshl_b32 s35, s42, 11
  s_add_u32 s37, s35, 69632
  s_sub_u32 s35, 69632, s35
  v_add_u32 v24, s37, v5
  v_add_u32 v25, s35, v5
  v_lshrrev_b32 v4, 3, v255
  v_lshrrev_b32 v5, 4, v255
  v_xor_b32 v4, v4, v5
  v_and_b32 v4, 1, v4
  v_cmp_eq_u32 vcc, 0, v4
  v_mov_b32 v6, 0x3f803f80
  s_nop 0
  v_cndmask_b32 v224, 0, v6, vcc
  v_cndmask_b32 v225, 0, v6, vcc
  v_cndmask_b32 v226, 0, v6, vcc
  v_cndmask_b32 v227, 0, v6, vcc
  s_cmp_eq_u32 s47, 1
  s_cselect_b32 s34, 0, 64
  s_cselect_b32 s24, 15, 31
  s_lshl_b32 s24, 1, s24
  s_cmp_eq_u32 s48, 1
  s_cselect_b32 s24, s24, 0x80008000
  s_mov_b32 s25, 0
  v_and_b32 v4, 1, v5
  v_add_u32 v4, s34, v4
  v_and_b32 v6, 15, v255
  v_lshlrev_b32 v6, 4, v6
  v_lshl_add_u32 v6, v4, 8, v6
  s_mul_i32 s35, s41, 16896
  v_add_u32 v36, s35, v6
  s_lshl_b32 s35, s41, 3
  s_add_u32 s35, s35, 145344
  v_lshl_add_u32 v37, v4, 5, s35
  v_bfe_u32 v4, v255, 3, 1
  v_lshlrev_b32 v6, 4, v5
  v_lshl_add_u32 v4, v4, 6, v6
  s_lshl_b32 s34, s41, 8
  s_add_u32 s34, s34, 67584
  v_add_u32 v228, s34, v4
  v_lshl_add_u32 v223, v230, 4, s34
  v_lshlrev_b32 v222, 4, v255
  s_lshl_b32 s23, s3, 16
  s_lshl_b32 s34, s43, 15
  s_add_u32 s23, s23, s34
  s_lshl_b32 s34, s40, 12
  s_add_u32 s23, s23, s34
  s_lshl_b32 s34, s42, 11
  s_add_u32 s23, s23, s34
  s_lshl_b32 s26, s40, 5
  s_add_u32 s26, s26, s3
  s_mul_i32 s26, s26, 8448
  s_lshl_b32 s35, s41, 11
  s_add_u32 s26, s26, s35
  s_add_u32 s26, s26, 12582912
  s_lshl_b32 s27, s3, 10
  s_add_u32 s27, s27, 19398656
  s_lshl_b32 s32, s40, 12
  s_add_u32 s32, s32, 19464192
  s_mov_b32 s33, 0x3f803f80
  s_mov_b32 s45, 0x3b000000
  s_mov_b32 s46, 0x3727c5ac
  s_mov_b32 s47, 0xc0135761
  s_mov_b32 s48, 0xbdd2d3e8
  s_mov_b32 s49, 0x3fb8aa3b
  s_mov_b32 s64, 0x14810
  v_lshlrev_b32 v4, 3, v0
  v_sub_u32 v4, 2047, v4
  v_cvt_f32_i32 v5, v4
  v_lshlrev_b32 v4, 2, v4
  v_add_u32 v4, 152080, v4
  v_add_f32 v6, 0x00000000, v5
  v_add_f32 v7, 0xbf800000, v5
  v_max_f32 v6, 0x43000000, v6
  v_max_f32 v7, 0x43000000, v7
  v_cvt_pk_bf16_f32 v6, v6, v7
  v_mad_u32_u16 v8, v6, 4, s64 op_sel:[0,0,0,0]
  v_subrev_u32 v9, 0, v4
  v_min_i32 v213, v8, v9
  v_mad_u32_u16 v8, v6, 4, s64 op_sel:[1,0,0,0]
  v_subrev_u32 v9, 4, v4
  v_min_i32 v214, v8, v9
  v_add_f32 v6, 0xc0000000, v5
  v_add_f32 v7, 0xc0400000, v5
  v_max_f32 v6, 0x43000000, v6
  v_max_f32 v7, 0x43000000, v7
  v_cvt_pk_bf16_f32 v6, v6, v7
  v_mad_u32_u16 v8, v6, 4, s64 op_sel:[0,0,0,0]
  v_subrev_u32 v9, 8, v4
  v_min_i32 v215, v8, v9
  v_mad_u32_u16 v8, v6, 4, s64 op_sel:[1,0,0,0]
  v_subrev_u32 v9, 12, v4
  v_min_i32 v216, v8, v9
  v_add_f32 v6, 0xc0800000, v5
  v_add_f32 v7, 0xc0a00000, v5
  v_max_f32 v6, 0x43000000, v6
  v_max_f32 v7, 0x43000000, v7
  v_cvt_pk_bf16_f32 v6, v6, v7
  v_mad_u32_u16 v8, v6, 4, s64 op_sel:[0,0,0,0]
  v_subrev_u32 v9, 16, v4
  v_min_i32 v217, v8, v9
  v_mad_u32_u16 v8, v6, 4, s64 op_sel:[1,0,0,0]
  v_subrev_u32 v9, 20, v4
  v_min_i32 v218, v8, v9
  v_add_f32 v6, 0xc0c00000, v5
  v_add_f32 v7, 0xc0e00000, v5
  v_max_f32 v6, 0x43000000, v6
  v_max_f32 v7, 0x43000000, v7
  v_cvt_pk_bf16_f32 v6, v6, v7
  v_mad_u32_u16 v8, v6, 4, s64 op_sel:[0,0,0,0]
  v_subrev_u32 v9, 24, v4
  v_min_i32 v219, v8, v9
  v_mad_u32_u16 v8, v6, 4, s64 op_sel:[1,0,0,0]
  v_subrev_u32 v9, 28, v4
  v_min_i32 v220, v8, v9
  v_add_f32 v6, 0xc1000000, v5
  v_add_f32 v7, 0xc1100000, v5
  v_max_f32 v6, 0x43000000, v6
  v_max_f32 v7, 0x43000000, v7
  v_cvt_pk_bf16_f32 v6, v6, v7
  v_mad_u32_u16 v8, v6, 4, s64 op_sel:[0,0,0,0]
  v_subrev_u32 v9, 32, v4
  v_min_i32 v221, v8, v9
  s_add_u32 m0, s51, 33280
  s_nop 0
  buffer_load_dwordx4 v12, s[52:55], 0 offen offset:512 lds
  buffer_load_dwordx4 v13, s[52:55], 0 offen offset:1536 lds
  buffer_load_dwordx4 v14, s[52:55], 0 offen offset:2560 lds
  buffer_load_dwordx4 v15, s[52:55], 0 offen offset:3584 lds
  s_add_u32 m0, s51, 49920
  s_nop 0
  buffer_load_dwordx4 v12, s[52:55], 0 offen offset:768 lds
  buffer_load_dwordx4 v13, s[52:55], 0 offen offset:1792 lds
  buffer_load_dwordx4 v14, s[52:55], 0 offen offset:2816 lds
  buffer_load_dwordx4 v15, s[52:55], 0 offen offset:3840 lds
  s_min_u32 s34, s3, 27
  s_lshl_b32 s34, s34, 2
  s_add_u32 s34, s34, s41
  s_lshl_b32 s34, s34, 14
  s_lshl_b32 s35, s40, 7
  s_add_u32 s64, s34, s35
  s_lshl_b32 s34, s3, 2
  s_add_u32 s34, s34, s41
  s_lshl_b32 s34, s34, 11
  s_lshl_b32 s35, s40, 18
  s_add_u32 s34, s34, s35
  s_add_u32 s65, s34, 20971520
  s_lshr_b32 s34, s64, 14
  s_mul_i32 s34, s34, 2341
  s_lshr_b32 s34, s34, 10
  s_and_b32 s67, s34, 64
  s_mul_i32 s66, s41, 2544
  s_add_u32 s66, s66, 135168
  s_waitcnt vmcnt(26)
  v_lshlrev_b32 v246, 16, v246
  s_waitcnt vmcnt(25)
  v_lshlrev_b32 v247, 16, v247
  s_waitcnt vmcnt(24)
  v_lshlrev_b32 v248, 16, v248
  s_waitcnt vmcnt(23)
  v_lshlrev_b32 v249, 16, v249
  s_waitcnt vmcnt(22)
  v_lshlrev_b32 v250, 16, v250
  s_waitcnt vmcnt(21)
  v_lshlrev_b32 v251, 16, v251
  s_waitcnt vmcnt(20)
  v_lshlrev_b32 v252, 16, v252
  s_waitcnt vmcnt(19)
  v_lshlrev_b32 v253, 16, v253
  v_mul_f32 v4, s49, v246
  v_mul_f32 v5, s49, v250
  v_exp_f32 v4, v4
  v_exp_f32 v5, v5
  s_add_u32 m0, s51, 69632
  s_add_u32 s39, s22, 0
  v_max3_f32 v7, |v248|, |v249|, |v252|
  v_cvt_pk_bf16_f32 v4, v4, v5
  v_max_f32 v7, |v253|, v7
  v_and_b32 v5, 0xffff0000, v4
  v_lshlrev_b32 v4, 16, v4
  v_mul_f32 v7, v7, v5
  v_mul_f32 v4, v4, v5
  v_mul_f32 v6, v247, v5
  v_max_f32_dpp v7, v7, v7 row_shr:1 row_mask:0xf bank_mask:0xf
  v_mul_f32 v40, v248, v5
  v_mul_f32 v41, v249, v5
  v_max_f32_dpp v7, v7, v7 row_shr:2 row_mask:0xf bank_mask:0xf
  buffer_load_dwordx4 v236, s[56:59], s39 offen offset:0 lds
  v_mul_f32 v4, 0xbfb8aa3b, v4
  v_mul_f32 v6, 0.15915494, v6
  v_max_f32_dpp v7, v7, v7 row_shr:4 row_mask:0xf bank_mask:0xf
  v_mul_f32 v8, 0x3f800000, v4
  v_mul_f32 v9, 0x3f800000, v6
  v_exp_f32 v8, v8
  v_fract_f32 v9, v9
  v_cos_f32 v2, v9
  v_sin_f32 v3, v9
  v_mul_f32 v2, v2, v8
  v_mul_f32 v3, v3, v8
  v_max_f32_dpp v7, v7, v7 row_shr:8 row_mask:0xf bank_mask:0xf
  buffer_load_dwordx4 v237, s[56:59], s39 offen offset:1024 lds
  v_mul_f32 v8, 0x41000000, v4
  v_mul_f32 v9, 0x41000000, v6
  v_exp_f32 v8, v8
  v_fract_f32 v9, v9
  v_cos_f32 v12, v9
  v_sin_f32 v13, v9
  v_mul_f32 v12, v12, v8
  v_mul_f32 v13, -v13, v8
  v_max_f32_dpp v7, v7, v7 row_bcast:15 row_mask:0xf bank_mask:0xf
  v_mul_f32 v8, 0x41800000, v4
  v_mul_f32 v9, 0x41800000, v6
  v_exp_f32 v8, v8
  buffer_load_dwordx4 v238, s[56:59], s39 offen offset:2048 lds
  v_fract_f32 v9, v9
  v_cos_f32 v38, v9
  v_sin_f32 v39, v9
  v_mul_f32 v38, v38, v8
  v_mul_f32 v39, -v39, v8
  v_max_f32_dpp v7, v7, v7 row_bcast:31 row_mask:0xf bank_mask:0xf
  v_mul_f32 v8, 0x43800000, v4
  v_mul_f32 v9, 0x43800000, v6
  v_exp_f32 v8, v8
  v_fract_f32 v9, v9
  v_cos_f32 v14, v9
  v_sin_f32 v15, v9
  buffer_load_dwordx4 v239, s[56:59], s39 offen offset:3072 lds
  v_mul_f32 v14, v14, v8
  v_mul_f32 v15, v15, v8
  v_readlane_b32 s34, v7, 63
  v_mov_b32 v10, 0x3c00
  v_accvgpr_write_b32 a222, v10
  s_lshr_b32 s34, s34, 23
  s_max_u32 s34, s34, 20
  s_min_u32 s34, s34, 240
  s_sub_u32 s35, 264, s34
  s_lshl_b32 s35, s35, 23
  s_sub_u32 s34, s34, 9
  s_lshl_b32 s68, s34, 23
  s_add_u32 m0, s51, 86016
  s_add_u32 s39, s22, 131072
  v_mul_f32 v40, s35, v40
  v_mul_f32 v41, s35, v41
  v_cvt_pk_f16_f32 v66, v12, v13
  v_accvgpr_write_b32 a223, v66
  v_cvt_pk_f16_f32 v67, v38, v39
  v_accvgpr_write_b32 a224, v67
  v_cvt_pk_f16_f32 v68, v40, v41
  v_accvgpr_write_b32 a200, v68
  v_pk_mul_f32 v[60:61], v[12:13], v[38:39] op_sel:[0,0] op_sel_hi:[0,1]
  v_pk_mul_f32 v[56:57], v[40:41], v[2:3] op_sel:[0,0] op_sel_hi:[0,1]
  v_pk_mul_f32 v[58:59], v[38:39], v[38:39] op_sel:[0,0] op_sel_hi:[0,1]
  v_pk_fma_f32 v[64:65], v[12:13], v[38:39], v[60:61] op_sel:[1,1,0] op_sel_hi:[1,0,1] neg_lo:[1,0,0]
  buffer_load_dwordx4 v236, s[56:59], s39 offen offset:0 lds
  v_pk_fma_f32 v[42:43], v[40:41], v[2:3], v[56:57] op_sel:[1,1,0] op_sel_hi:[1,0,1] neg_lo:[1,0,0]
  v_pk_fma_f32 v[62:63], v[38:39], v[38:39], v[58:59] op_sel:[1,1,0] op_sel_hi:[1,0,1] neg_lo:[1,0,0]
  v_cvt_pk_f16_f32 v67, v64, v65
  v_cvt_pk_f16_f32 v68, v42, v43
  v_cvt_pk_f16_f32 v66, v62, v63
  v_accvgpr_write_b32 a225, v67
  v_accvgpr_write_b32 a201, v68
  v_accvgpr_write_b32 a226, v66
  v_pk_mul_f32 v[60:61], v[64:65], v[38:39] op_sel:[0,0] op_sel_hi:[0,1]
  v_pk_mul_f32 v[56:57], v[42:43], v[2:3] op_sel:[0,0] op_sel_hi:[0,1]
  v_pk_mul_f32 v[58:59], v[62:63], v[38:39] op_sel:[0,0] op_sel_hi:[0,1]
  v_pk_fma_f32 v[64:65], v[64:65], v[38:39], v[60:61] op_sel:[1,1,0] op_sel_hi:[1,0,1] neg_lo:[1,0,0]
  buffer_load_dwordx4 v237, s[56:59], s39 offen offset:1024 lds
  v_pk_fma_f32 v[44:45], v[42:43], v[2:3], v[56:57] op_sel:[1,1,0] op_sel_hi:[1,0,1] neg_lo:[1,0,0]
  v_pk_fma_f32 v[62:63], v[62:63], v[38:39], v[58:59] op_sel:[1,1,0] op_sel_hi:[1,0,1] neg_lo:[1,0,0]
  v_cvt_pk_f16_f32 v67, v64, v65
  v_cvt_pk_f16_f32 v68, v44, v45
  v_cvt_pk_f16_f32 v66, v62, v63
  v_accvgpr_write_b32 a227, v67
  v_accvgpr_write_b32 a202, v68
  v_accvgpr_write_b32 a228, v66
  v_pk_mul_f32 v[60:61], v[64:65], v[38:39] op_sel:[0,0] op_sel_hi:[0,1]
  v_pk_mul_f32 v[56:57], v[44:45], v[2:3] op_sel:[0,0] op_sel_hi:[0,1]
  v_pk_mul_f32 v[58:59], v[62:63], v[38:39] op_sel:[0,0] op_sel_hi:[0,1]
  v_pk_fma_f32 v[64:65], v[64:65], v[38:39], v[60:61] op_sel:[1,1,0] op_sel_hi:[1,0,1] neg_lo:[1,0,0]
  buffer_load_dwordx4 v238, s[56:59], s39 offen offset:2048 lds
  v_pk_fma_f32 v[46:47], v[44:45], v[2:3], v[56:57] op_sel:[1,1,0] op_sel_hi:[1,0,1] neg_lo:[1,0,0]
  v_pk_fma_f32 v[62:63], v[62:63], v[38:39], v[58:59] op_sel:[1,1,0] op_sel_hi:[1,0,1] neg_lo:[1,0,0]
  v_cvt_pk_f16_f32 v67, v64, v65
  v_cvt_pk_f16_f32 v68, v46, v47
  v_cvt_pk_f16_f32 v66, v62, v63
  v_accvgpr_write_b32 a229, v67
  v_accvgpr_write_b32 a203, v68
  v_accvgpr_write_b32 a230, v66
  v_pk_mul_f32 v[60:61], v[64:65], v[38:39] op_sel:[0,0] op_sel_hi:[0,1]
  v_pk_mul_f32 v[56:57], v[46:47], v[2:3] op_sel:[0,0] op_sel_hi:[0,1]
  v_pk_mul_f32 v[58:59], v[62:63], v[38:39] op_sel:[0,0] op_sel_hi:[0,1]
  v_pk_fma_f32 v[64:65], v[64:65], v[38:39], v[60:61] op_sel:[1,1,0] op_sel_hi:[1,0,1] neg_lo:[1,0,0]
  buffer_load_dwordx4 v239, s[56:59], s39 offen offset:3072 lds
  v_pk_fma_f32 v[48:49], v[46:47], v[2:3], v[56:57] op_sel:[1,1,0] op_sel_hi:[1,0,1] neg_lo:[1,0,0]
  v_pk_fma_f32 v[62:63], v[62:63], v[38:39], v[58:59] op_sel:[1,1,0] op_sel_hi:[1,0,1] neg_lo:[1,0,0]
  v_cvt_pk_f16_f32 v67, v64, v65
  v_cvt_pk_f16_f32 v68, v48, v49
  v_cvt_pk_f16_f32 v66, v62, v63
  v_accvgpr_write_b32 a231, v67
  v_accvgpr_write_b32 a204, v68
  v_accvgpr_write_b32 a232, v66
  v_pk_mul_f32 v[60:61], v[64:65], v[38:39] op_sel:[0,0] op_sel_hi:[0,1]
  v_pk_mul_f32 v[56:57], v[48:49], v[2:3] op_sel:[0,0] op_sel_hi:[0,1]
  v_pk_mul_f32 v[58:59], v[62:63], v[38:39] op_sel:[0,0] op_sel_hi:[0,1]
  v_pk_fma_f32 v[64:65], v[64:65], v[38:39], v[60:61] op_sel:[1,1,0] op_sel_hi:[1,0,1] neg_lo:[1,0,0]
  s_add_u32 m0, s51, 102400
  s_add_u32 s39, s22, 262144
  v_pk_fma_f32 v[50:51], v[48:49], v[2:3], v[56:57] op_sel:[1,1,0] op_sel_hi:[1,0,1] neg_lo:[1,0,0]
  v_pk_fma_f32 v[62:63], v[62:63], v[38:39], v[58:59] op_sel:[1,1,0] op_sel_hi:[1,0,1] neg_lo:[1,0,0]
  v_cvt_pk_f16_f32 v67, v64, v65
  v_cvt_pk_f16_f32 v68, v50, v51
  v_cvt_pk_f16_f32 v66, v62, v63
  v_accvgpr_write_b32 a233, v67
  v_accvgpr_write_b32 a205, v68
  v_accvgpr_write_b32 a234, v66
  v_pk_mul_f32 v[60:61], v[64:65], v[38:39] op_sel:[0,0] op_sel_hi:[0,1]
  v_pk_mul_f32 v[56:57], v[50:51], v[2:3] op_sel:[0,0] op_sel_hi:[0,1]
  v_pk_mul_f32 v[58:59], v[62:63], v[38:39] op_sel:[0,0] op_sel_hi:[0,1]
  v_pk_fma_f32 v[64:65], v[64:65], v[38:39], v[60:61] op_sel:[1,1,0] op_sel_hi:[1,0,1] neg_lo:[1,0,0]
  buffer_load_dwordx4 v236, s[56:59], s39 offen offset:0 lds
  v_pk_fma_f32 v[52:53], v[50:51], v[2:3], v[56:57] op_sel:[1,1,0] op_sel_hi:[1,0,1] neg_lo:[1,0,0]
  v_pk_fma_f32 v[62:63], v[62:63], v[38:39], v[58:59] op_sel:[1,1,0] op_sel_hi:[1,0,1] neg_lo:[1,0,0]
  v_cvt_pk_f16_f32 v67, v64, v65
  v_cvt_pk_f16_f32 v68, v52, v53
  v_cvt_pk_f16_f32 v66, v62, v63
  v_accvgpr_write_b32 a235, v67
  v_accvgpr_write_b32 a206, v68
  v_accvgpr_write_b32 a236, v66
  v_pk_mul_f32 v[60:61], v[64:65], v[38:39] op_sel:[0,0] op_sel_hi:[0,1]
  v_pk_mul_f32 v[56:57], v[52:53], v[2:3] op_sel:[0,0] op_sel_hi:[0,1]
  v_pk_mul_f32 v[58:59], v[62:63], v[38:39] op_sel:[0,0] op_sel_hi:[0,1]
  v_pk_fma_f32 v[64:65], v[64:65], v[38:39], v[60:61] op_sel:[1,1,0] op_sel_hi:[1,0,1] neg_lo:[1,0,0]
  buffer_load_dwordx4 v237, s[56:59], s39 offen offset:1024 lds
  v_pk_fma_f32 v[54:55], v[52:53], v[2:3], v[56:57] op_sel:[1,1,0] op_sel_hi:[1,0,1] neg_lo:[1,0,0]
  v_pk_fma_f32 v[62:63], v[62:63], v[38:39], v[58:59] op_sel:[1,1,0] op_sel_hi:[1,0,1] neg_lo:[1,0,0]
  v_cvt_pk_f16_f32 v67, v64, v65
  v_cvt_pk_f16_f32 v68, v54, v55
  v_cvt_pk_f16_f32 v66, v62, v63
  v_accvgpr_write_b32 a237, v67
  v_accvgpr_write_b32 a207, v68
  v_accvgpr_write_b32 a238, v66
  v_pk_mul_f32 v[56:57], v[40:41], v[14:15] op_sel:[0,0] op_sel_hi:[0,1]
  v_pk_fma_f32 v[40:41], v[40:41], v[14:15], v[56:57] op_sel:[1,1,0] op_sel_hi:[1,0,1] neg_lo:[1,0,0]
  v_cvt_pk_f16_f32 v68, v40, v41
  v_accvgpr_write_b32 a208, v68
  buffer_load_dwordx4 v238, s[56:59], s39 offen offset:2048 lds
  v_pk_mul_f32 v[56:57], v[44:45], v[14:15] op_sel:[0,0] op_sel_hi:[0,1]
  v_pk_fma_f32 v[44:45], v[44:45], v[14:15], v[56:57] op_sel:[1,1,0] op_sel_hi:[1,0,1] neg_lo:[1,0,0]
  v_cvt_pk_f16_f32 v68, v44, v45
  v_accvgpr_write_b32 a209, v68
  v_pk_mul_f32 v[56:57], v[48:49], v[14:15] op_sel:[0,0] op_sel_hi:[0,1]
  v_pk_fma_f32 v[48:49], v[48:49], v[14:15], v[56:57] op_sel:[1,1,0] op_sel_hi:[1,0,1] neg_lo:[1,0,0]
  v_cvt_pk_f16_f32 v68, v48, v49
  v_accvgpr_write_b32 a210, v68
  v_pk_mul_f32 v[56:57], v[52:53], v[14:15] op_sel:[0,0] op_sel_hi:[0,1]
  v_pk_fma_f32 v[52:53], v[52:53], v[14:15], v[56:57] op_sel:[1,1,0] op_sel_hi:[1,0,1] neg_lo:[1,0,0]
  v_cvt_pk_f16_f32 v68, v52, v53
  v_accvgpr_write_b32 a211, v68
  buffer_load_dwordx4 v239, s[56:59], s39 offen offset:3072 lds
  v_pk_mul_f32 v[56:57], v[40:41], v[14:15] op_sel:[0,0] op_sel_hi:[0,1]
  v_pk_fma_f32 v[40:41], v[40:41], v[14:15], v[56:57] op_sel:[1,1,0] op_sel_hi:[1,0,1] neg_lo:[1,0,0]
  v_cvt_pk_f16_f32 v68, v40, v41
  v_accvgpr_write_b32 a212, v68
  v_pk_mul_f32 v[56:57], v[48:49], v[14:15] op_sel:[0,0] op_sel_hi:[0,1]
  v_pk_fma_f32 v[48:49], v[48:49], v[14:15], v[56:57] op_sel:[1,1,0] op_sel_hi:[1,0,1] neg_lo:[1,0,0]
  v_cvt_pk_f16_f32 v68, v48, v49
  v_accvgpr_write_b32 a213, v68
  v_pk_mul_f32 v[56:57], v[40:41], v[14:15] op_sel:[0,0] op_sel_hi:[0,1]
  v_pk_fma_f32 v[40:41], v[40:41], v[14:15], v[56:57] op_sel:[1,1,0] op_sel_hi:[1,0,1] neg_lo:[1,0,0]
  v_cvt_pk_f16_f32 v68, v40, v41
  v_accvgpr_write_b32 a214, v68
  s_add_u32 m0, s51, 118784
  s_add_u32 s39, s22, 393216
  v_pk_mul_f32 v[56:57], v[48:49], v[14:15] op_sel:[0,0] op_sel_hi:[0,1]
  v_pk_fma_f32 v[48:49], v[48:49], v[14:15], v[56:57] op_sel:[1,1,0] op_sel_hi:[1,0,1] neg_lo:[1,0,0]
  v_cvt_pk_f16_f32 v68, v48, v49
  v_accvgpr_write_b32 a215, v68
  v_pk_mul_f32 v[56:57], v[40:41], v[14:15] op_sel:[0,0] op_sel_hi:[0,1]
  v_pk_fma_f32 v[40:41], v[40:41], v[14:15], v[56:57] op_sel:[1,1,0] op_sel_hi:[1,0,1] neg_lo:[1,0,0]
  v_cvt_pk_f16_f32 v68, v40, v41
  v_accvgpr_write_b32 a216, v68
  v_pk_mul_f32 v[56:57], v[40:41], v[14:15] op_sel:[0,0] op_sel_hi:[0,1]
  v_pk_fma_f32 v[40:41], v[40:41], v[14:15], v[56:57] op_sel:[1,1,0] op_sel_hi:[1,0,1] neg_lo:[1,0,0]
  v_cvt_pk_f16_f32 v68, v40, v41
  v_accvgpr_write_b32 a217, v68
  buffer_load_dwordx4 v236, s[56:59], s39 offen offset:0 lds
  v_pk_mul_f32 v[56:57], v[40:41], v[14:15] op_sel:[0,0] op_sel_hi:[0,1]
  v_pk_fma_f32 v[40:41], v[40:41], v[14:15], v[56:57] op_sel:[1,1,0] op_sel_hi:[1,0,1] neg_lo:[1,0,0]
  v_cvt_pk_f16_f32 v68, v40, v41
  v_accvgpr_write_b32 a218, v68
  v_pk_mul_f32 v[56:57], v[40:41], v[14:15] op_sel:[0,0] op_sel_hi:[0,1]
  v_pk_fma_f32 v[40:41], v[40:41], v[14:15], v[56:57] op_sel:[1,1,0] op_sel_hi:[1,0,1] neg_lo:[1,0,0]
  v_cvt_pk_f16_f32 v68, v40, v41
  v_accvgpr_write_b32 a219, v68
  v_pk_mul_f32 v[56:57], v[40:41], v[14:15] op_sel:[0,0] op_sel_hi:[0,1]
  v_pk_fma_f32 v[40:41], v[40:41], v[14:15], v[56:57] op_sel:[1,1,0] op_sel_hi:[1,0,1] neg_lo:[1,0,0]
  v_cvt_pk_f16_f32 v68, v40, v41
  v_accvgpr_write_b32 a220, v68
  buffer_load_dwordx4 v237, s[56:59], s39 offen offset:1024 lds
  buffer_load_dwordx4 v238, s[56:59], s39 offen offset:2048 lds
  buffer_load_dwordx4 v239, s[56:59], s39 offen offset:3072 lds
  s_mov_b32 m0, s66
  s_nop 0
  buffer_load_dwordx4 v236, s[12:15], s64 offen offset:0 lds
  buffer_load_dwordx4 v237, s[12:15], s64 offen offset:1024 lds
  buffer_load_dword v254, v240, s[4:7], 0 offen
  buffer_load_dword v254, v241, s[8:11], 0 offen
  s_lshl_b32 s76, s41, 14
  v_add_u32 v2, s76, v231
  v_xor_b32 v3, 64, v2
  s_lshl_b32 s75, s41, 12
  s_add_u32 s75, s75, 135680
  s_lshl_b32 s69, s41, 13
  s_add_u32 s69, s69, 102912
  s_mul_i32 s71, s40, 448
  s_lshl_b32 s34, s41, 7
  s_add_u32 s71, s71, s34
  s_lshl_b32 s34, s3, 1
  s_add_u32 s34, s34, s40
  s_lshl_b32 s34, s34, 1
  s_and_b32 s73, s34, 0
  s_add_u32 s72, s71, 1835008
  s_mul_i32 s70, s73, 114688
  s_add_u32 s70, s70, s71
  s_lshl_b32 s34, s40, 16
  s_and_b32 s34, s34, 0
  s_add_u32 s74, s22, s34
  v_add_u32 v252, s69, v231
  v_xor_b32 v253, 64, v252
  v_add_u32 v248, s75, v231
  v_xor_b32 v249, 64, v248
  v_mov_b32 v4, 0
  v_mov_b32 v5, 0
  v_mov_b32 v6, 0
  v_mov_b32 v7, 0
  s_waitcnt vmcnt(20)
  s_barrier
  ds_read_b128 v[68:71], v16 offset:0
  ds_read_b128 v[72:75], v18 offset:0
  ds_read_b128 v[76:79], v20 offset:0
  ds_read_b128 v[80:83], v22 offset:0
  ds_read_b128 v[84:87], v16 offset:16896
  ds_read_b128 v[88:91], v18 offset:16896
  ds_read_b128 v[8:11], v36
  s_waitcnt lgkmcnt(6)
  v_dot2c_f32_bf16 v4, s33, v68
  v_dot2c_f32_bf16 v5, v68, v68
  v_dot2c_f32_bf16 v4, s33, v69
  v_dot2c_f32_bf16 v5, v69, v69
  v_dot2c_f32_bf16 v4, s33, v70
  v_dot2c_f32_bf16 v5, v70, v70
  v_dot2c_f32_bf16 v4, s33, v71
  v_dot2c_f32_bf16 v5, v71, v71
  ds_read_b128 v[92:95], v20 offset:16896
  ds_read_b128 a[64:67], v17 offset:0
  s_waitcnt lgkmcnt(7)
  v_dot2c_f32_bf16 v4, s33, v72
  v_dot2c_f32_bf16 v5, v72, v72
  s_add_u32 m0, s75, 11776
  v_dot2c_f32_bf16 v4, s33, v73
  v_dot2c_f32_bf16 v5, v73, v73
  v_dot2c_f32_bf16 v4, s33, v74
  v_dot2c_f32_bf16 v5, v74, v74
  v_dot2c_f32_bf16 v4, s33, v75
  v_dot2c_f32_bf16 v5, v75, v75
  ds_read_b128 v[96:99], v22 offset:16896
  ds_read_b128 a[68:71], v19 offset:0
  s_waitcnt lgkmcnt(8)
  v_dot2c_f32_bf16 v4, s33, v76
  v_dot2c_f32_bf16 v5, v76, v76
  v_dot2c_f32_bf16 v4, s33, v77
  buffer_load_dwordx4 v232, s[8:11], s70 offen offset:0 lds
  v_dot2c_f32_bf16 v5, v77, v77
  v_dot2c_f32_bf16 v4, s33, v78
  v_dot2c_f32_bf16 v5, v78, v78
  v_dot2c_f32_bf16 v4, s33, v79
  v_dot2c_f32_bf16 v5, v79, v79
  ds_read_b128 v[100:103], v16 offset:33792
  ds_read_b128 a[72:75], v21 offset:0
  s_waitcnt lgkmcnt(9)
  v_dot2c_f32_bf16 v4, s33, v80
  v_dot2c_f32_bf16 v5, v80, v80
  v_dot2c_f32_bf16 v4, s33, v81
  v_dot2c_f32_bf16 v5, v81, v81
  buffer_load_dwordx4 v233, s[8:11], s70 offen offset:1024 lds
  v_dot2c_f32_bf16 v4, s33, v82
  v_dot2c_f32_bf16 v5, v82, v82
  v_dot2c_f32_bf16 v4, s33, v83
  v_dot2c_f32_bf16 v5, v83, v83
  ds_read_b128 v[104:107], v18 offset:33792
  ds_read_b128 a[76:79], v23 offset:0
  s_waitcnt lgkmcnt(8)
  v_dot2c_f32_bf16 v6, s33, v8
  v_dot2c_f32_bf16 v7, v8, v8
  v_dot2c_f32_bf16 v6, s33, v9
  v_dot2c_f32_bf16 v7, v9, v9
  v_dot2c_f32_bf16 v6, s33, v10
  buffer_load_dwordx4 v234, s[8:11], s70 offen offset:2048 lds
  v_dot2c_f32_bf16 v7, v10, v10
  v_dot2c_f32_bf16 v6, s33, v11
  v_dot2c_f32_bf16 v7, v11, v11
  v_dot2c_f32_bf16 v4, s33, v84
  v_dot2c_f32_bf16 v5, v84, v84
  v_dot2c_f32_bf16 v4, s33, v85
  v_dot2c_f32_bf16 v5, v85, v85
  v_dot2c_f32_bf16 v4, s33, v86
  v_dot2c_f32_bf16 v5, v86, v86
  v_dot2c_f32_bf16 v4, s33, v87
  v_dot2c_f32_bf16 v5, v87, v87
  buffer_load_dwordx4 v235, s[8:11], s70 offen offset:3072 lds
  ds_read_b128 v[108:111], v20 offset:33792
  ds_read_b128 a[80:83], v17 offset:16896
  v_dot2c_f32_bf16 v4, s33, v88
  v_dot2c_f32_bf16 v5, v88, v88
  v_dot2c_f32_bf16 v4, s33, v89
  v_dot2c_f32_bf16 v5, v89, v89
  v_dot2c_f32_bf16 v4, s33, v90
  v_dot2c_f32_bf16 v5, v90, v90
  v_dot2c_f32_bf16 v4, s33, v91
  v_dot2c_f32_bf16 v5, v91, v91
  ds_read_b128 v[112:115], v22 offset:33792
  v_mov_b32 v1, 0
  ds_read_b128 a[84:87], v19 offset:16896
  v_add_f32_dpp v6, v6, v6 row_shr:1 row_mask:0xf bank_mask:0xf bound_ctrl:0
  v_add_f32_dpp v7, v7, v7 row_shr:1 row_mask:0xf bank_mask:0xf bound_ctrl:0
  s_waitcnt lgkmcnt(11)
  v_dot2c_f32_bf16 v4, s33, v92
  v_dot2c_f32_bf16 v5, v92, v92
  v_dot2c_f32_bf16 v4, s33, v93
  v_dot2c_f32_bf16 v5, v93, v93
  v_dot2c_f32_bf16 v4, s33, v94
  v_dot2c_f32_bf16 v5, v94, v94
  v_dot2c_f32_bf16 v4, s33, v95
  v_dot2c_f32_bf16 v5, v95, v95
  global_load_dwordx2 v[244:245], v1, s[30:31] sc1
  ds_read_b128 v[116:119], v16 offset:50688
  ds_read_b128 a[88:91], v21 offset:16896
  v_add_f32_dpp v6, v6, v6 row_shr:2 row_mask:0xf bank_mask:0xf bound_ctrl:0
  v_add_f32_dpp v7, v7, v7 row_shr:2 row_mask:0xf bank_mask:0xf bound_ctrl:0
  s_waitcnt lgkmcnt(11)
  v_dot2c_f32_bf16 v4, s33, v96
  v_dot2c_f32_bf16 v5, v96, v96
  v_dot2c_f32_bf16 v4, s33, v97
  v_dot2c_f32_bf16 v5, v97, v97
  v_dot2c_f32_bf16 v4, s33, v98
  v_dot2c_f32_bf16 v5, v98, v98
  v_dot2c_f32_bf16 v4, s33, v99
  v_dot2c_f32_bf16 v5, v99, v99
  ds_read_b128 v[120:123], v18 offset:50688
  ds_read_b128 a[92:95], v23 offset:16896
  v_add_f32_dpp v6, v6, v6 row_shr:4 row_mask:0xf bank_mask:0xf bound_ctrl:0
  v_add_f32_dpp v7, v7, v7 row_shr:4 row_mask:0xf bank_mask:0xf bound_ctrl:0
  s_waitcnt lgkmcnt(11)
  v_dot2c_f32_bf16 v4, s33, v100
  v_dot2c_f32_bf16 v5, v100, v100
  v_dot2c_f32_bf16 v4, s33, v101
  v_dot2c_f32_bf16 v5, v101, v101
  v_dot2c_f32_bf16 v4, s33, v102
  v_dot2c_f32_bf16 v5, v102, v102
  v_dot2c_f32_bf16 v4, s33, v103
  v_dot2c_f32_bf16 v5, v103, v103
  ds_read_b128 v[124:127], v20 offset:50688
  ds_read_b128 a[96:99], v17 offset:33792
  v_add_f32_dpp v6, v6, v6 row_shr:8 row_mask:0xf bank_mask:0xf bound_ctrl:0
  v_add_f32_dpp v7, v7, v7 row_shr:8 row_mask:0xf bank_mask:0xf bound_ctrl:0
  s_waitcnt lgkmcnt(11)
  v_dot2c_f32_bf16 v4, s33, v104
  v_dot2c_f32_bf16 v5, v104, v104
  v_dot2c_f32_bf16 v4, s33, v105
  v_dot2c_f32_bf16 v5, v105, v105
  v_dot2c_f32_bf16 v4, s33, v106
  v_dot2c_f32_bf16 v5, v106, v106
  v_dot2c_f32_bf16 v4, s33, v107
  v_dot2c_f32_bf16 v5, v107, v107
  ds_read_b128 v[128:131], v22 offset:50688
  ds_read_b128 a[100:103], v19 offset:33792
  s_waitcnt lgkmcnt(11)
  v_dot2c_f32_bf16 v4, s33, v108
  v_dot2c_f32_bf16 v5, v108, v108
  v_dot2c_f32_bf16 v4, s33, v109
  v_dot2c_f32_bf16 v5, v109, v109
  v_dot2c_f32_bf16 v4, s33, v110
  v_dot2c_f32_bf16 v5, v110, v110
  v_dot2c_f32_bf16 v4, s33, v111
  v_dot2c_f32_bf16 v5, v111, v111
  ds_read_b128 a[104:107], v21 offset:33792
  ds_read_b64 v[204:205], v32
  ds_read_b64 v[206:207], v33
  ds_read_b64 v[208:209], v34
  ds_read_b64 v[210:211], v35
  s_waitcnt lgkmcnt(14)
  v_dot2c_f32_bf16 v4, s33, v112
  v_dot2c_f32_bf16 v5, v112, v112
  v_dot2c_f32_bf16 v4, s33, v113
  v_dot2c_f32_bf16 v5, v113, v113
  v_dot2c_f32_bf16 v4, s33, v114
  v_dot2c_f32_bf16 v5, v114, v114
  v_dot2c_f32_bf16 v4, s33, v115
  v_dot2c_f32_bf16 v5, v115, v115
  ds_read_b128 a[108:111], v23 offset:33792
  s_waitcnt lgkmcnt(13)
  v_dot2c_f32_bf16 v4, s33, v116
  v_dot2c_f32_bf16 v5, v116, v116
  v_dot2c_f32_bf16 v4, s33, v117
  v_dot2c_f32_bf16 v5, v117, v117
  v_dot2c_f32_bf16 v4, s33, v118
  v_dot2c_f32_bf16 v5, v118, v118
  v_dot2c_f32_bf16 v4, s33, v119
  v_dot2c_f32_bf16 v5, v119, v119
  ds_read_b128 a[112:115], v17 offset:50688
  s_waitcnt lgkmcnt(12)
  v_dot2c_f32_bf16 v4, s33, v120
  v_dot2c_f32_bf16 v5, v120, v120
  v_dot2c_f32_bf16 v4, s33, v121
  v_dot2c_f32_bf16 v5, v121, v121
  v_dot2c_f32_bf16 v4, s33, v122
  v_dot2c_f32_bf16 v5, v122, v122
  v_dot2c_f32_bf16 v4, s33, v123
  v_dot2c_f32_bf16 v5, v123, v123
  ds_read_b128 a[116:119], v19 offset:50688
  s_waitcnt lgkmcnt(11)
  v_dot2c_f32_bf16 v4, s33, v124
  v_dot2c_f32_bf16 v5, v124, v124
  v_dot2c_f32_bf16 v4, s33, v125
  v_dot2c_f32_bf16 v5, v125, v125
  v_dot2c_f32_bf16 v4, s33, v126
  v_dot2c_f32_bf16 v5, v126, v126
  v_dot2c_f32_bf16 v4, s33, v127
  v_dot2c_f32_bf16 v5, v127, v127
  ds_read_b128 a[120:123], v21 offset:50688
  s_waitcnt lgkmcnt(10)
  v_dot2c_f32_bf16 v4, s33, v128
  v_dot2c_f32_bf16 v5, v128, v128
  v_dot2c_f32_bf16 v4, s33, v129
  v_dot2c_f32_bf16 v5, v129, v129
  v_dot2c_f32_bf16 v4, s33, v130
  v_dot2c_f32_bf16 v5, v130, v130
  v_dot2c_f32_bf16 v4, s33, v131
  v_dot2c_f32_bf16 v5, v131, v131
  ds_read_b128 a[124:127], v23 offset:50688
  s_mov_b64 exec, s[24:25]
  ds_write_b64 v37, v[6:7]
  s_mov_b64 exec, -1
  ds_write_b64 v26, v[4:5]
  s_waitcnt vmcnt(17)
  s_waitcnt lgkmcnt(0)
  s_barrier
  ds_read_b64_tr_b16 v[132:133], v24 offset:0
  ds_read_b64_tr_b16 v[134:135], v24 offset:512
  ds_read_b64_tr_b16 v[136:137], v25 offset:2048
  ds_read_b64_tr_b16 v[138:139], v25 offset:2560
  ds_read_b64_tr_b16 v[140:141], v24 offset:4096
  ds_read_b64_tr_b16 v[142:143], v24 offset:4608
  ds_read_b64_tr_b16 v[144:145], v25 offset:6144
  ds_read_b64_tr_b16 v[146:147], v25 offset:6656
  ds_read_b64_tr_b16 v[148:149], v24 offset:8192
  ds_read_b64_tr_b16 v[150:151], v24 offset:8704
  s_waitcnt lgkmcnt(6)
  v_mfma_f32_32x32x16_bf16 v[4:19], v[132:135], v[68:71], 0
  ds_read_b64_tr_b16 v[152:153], v25 offset:10240
  ds_read_b64_tr_b16 v[154:155], v25 offset:10752
  s_add_u32 m0, s76, 0
  s_add_u32 s70, s70, 114688
  s_cmp_eq_u32 s70, s72
  s_cselect_b32 s70, s71, s70
  v_mfma_f32_16x16x32_bf16 v[20:23], v[132:135], v[224:227], 0
  ds_read_b128 v[40:43], v27
  ds_read_b128 v[44:47], v27 offset:16
  v_mfma_f32_32x32x16_bf16 v[4:19], v[136:139], a[64:67], v[4:19]
  ds_read_b64_tr_b16 v[132:133], v24 offset:12288
  ds_read_b64_tr_b16 v[134:135], v24 offset:12800
  buffer_load_dwordx4 v232, s[8:11], s70 offen offset:0 lds
  ds_read_b128 v[48:51], v28
  v_mfma_f32_16x16x32_bf16 v[20:23], v[136:139], v[224:227], v[20:23]
  ds_read_b128 v[52:55], v28 offset:16
  v_lshlrev_b32 v188, 16, v204
  s_waitcnt lgkmcnt(10)
  v_mfma_f32_32x32x16_bf16 v[4:19], v[140:143], v[72:75], v[4:19]
  ds_read_b64_tr_b16 v[136:137], v25 offset:14336
  ds_read_b64_tr_b16 v[138:139], v25 offset:14848
  buffer_load_dwordx4 v233, s[8:11], s70 offen offset:1024 lds
  v_mfma_f32_16x16x32_bf16 v[20:23], v[140:143], v[224:227], v[20:23]
  v_lshlrev_b32 v190, 16, v205
  v_lshlrev_b32 v192, 16, v206
  v_mfma_f32_32x32x16_bf16 v[4:19], v[144:147], a[68:71], v[4:19]
  ds_read_b64_tr_b16 v[140:141], v24 offset:16384
  ds_read_b64_tr_b16 v[142:143], v24 offset:16896
  buffer_load_dwordx4 v234, s[8:11], s70 offen offset:2048 lds
  v_lshlrev_b32 v194, 16, v207
  v_mfma_f32_16x16x32_bf16 v[20:23], v[144:147], v[224:227], v[20:23]
  v_lshlrev_b32 v196, 16, v208
  v_lshlrev_b32 v198, 16, v209
  s_waitcnt lgkmcnt(10)
  v_mfma_f32_32x32x16_bf16 v[4:19], v[148:151], v[76:79], v[4:19]
  ds_read_b64_tr_b16 v[144:145], v25 offset:18432
  ds_read_b64_tr_b16 v[146:147], v25 offset:18944
  buffer_load_dwordx4 v235, s[8:11], s70 offen offset:3072 lds
  v_mfma_f32_16x16x32_bf16 v[20:23], v[148:151], v[224:227], v[20:23]
  v_lshlrev_b32 v200, 16, v210
  v_lshlrev_b32 v202, 16, v211
  v_mfma_f32_32x32x16_bf16 v[4:19], v[152:155], a[72:75], v[4:19]
  ds_read_b64_tr_b16 v[148:149], v24 offset:20480
  ds_read_b64_tr_b16 v[150:151], v24 offset:20992
  s_add_u32 m0, s76, 4096
  s_add_u32 s70, s70, 114688
  s_cmp_eq_u32 s70, s72
  s_cselect_b32 s70, s71, s70
  v_and_b32 v189, 0xffff0000, v204
  v_mfma_f32_16x16x32_bf16 v[20:23], v[152:155], v[224:227], v[20:23]
  v_and_b32 v191, 0xffff0000, v205
  v_and_b32 v193, 0xffff0000, v206
  s_waitcnt lgkmcnt(6)
  v_mfma_f32_32x32x16_bf16 v[4:19], v[132:135], v[80:83], v[4:19]
  ds_read_b64_tr_b16 v[152:153], v25 offset:22528
  ds_read_b64_tr_b16 v[154:155], v25 offset:23040
  buffer_load_dwordx4 v232, s[8:11], s70 offen offset:0 lds
  v_mfma_f32_16x16x32_bf16 v[20:23], v[132:135], v[224:227], v[20:23]
  v_and_b32 v195, 0xffff0000, v207
  v_and_b32 v197, 0xffff0000, v208
  v_mfma_f32_32x32x16_bf16 v[4:19], v[136:139], a[76:79], v[4:19]
  ds_read_b64_tr_b16 v[132:133], v24 offset:24576
  ds_read_b64_tr_b16 v[134:135], v24 offset:25088
  buffer_load_dwordx4 v233, s[8:11], s70 offen offset:1024 lds
  v_and_b32 v199, 0xffff0000, v209
  v_mfma_f32_16x16x32_bf16 v[20:23], v[136:139], v[224:227], v[20:23]
  v_and_b32 v201, 0xffff0000, v210
  v_and_b32 v203, 0xffff0000, v211
  s_waitcnt lgkmcnt(6)
  v_mfma_f32_32x32x16_bf16 v[4:19], v[140:143], v[84:87], v[4:19]
  ds_read_b64_tr_b16 v[136:137], v25 offset:26624
  ds_read_b64_tr_b16 v[138:139], v25 offset:27136
  buffer_load_dwordx4 v234, s[8:11], s70 offen offset:2048 lds
  v_mfma_f32_16x16x32_bf16 v[20:23], v[140:143], v[224:227], v[20:23]
  v_add_f32 v48, v48, v50
  v_add_f32 v49, v49, v51
  v_mfma_f32_32x32x16_bf16 v[4:19], v[144:147], a[80:83], v[4:19]
  ds_read_b64_tr_b16 v[140:141], v24 offset:28672
  ds_read_b64_tr_b16 v[142:143], v24 offset:29184
  buffer_load_dwordx4 v235, s[8:11], s70 offen offset:3072 lds
  v_add_f32 v52, v52, v54
  v_mfma_f32_16x16x32_bf16 v[20:23], v[144:147], v[224:227], v[20:23]
  v_add_f32 v53, v53, v55
  v_add_f32 v48, v48, v52
  s_waitcnt lgkmcnt(6)
  v_mfma_f32_32x32x16_bf16 v[4:19], v[148:151], v[88:91], v[4:19]
  ds_read_b64_tr_b16 v[144:145], v25 offset:30720
  ds_read_b64_tr_b16 v[146:147], v25 offset:31232
  s_add_u32 m0, s76, 8192
  s_add_u32 s70, s70, 114688
  s_cmp_eq_u32 s70, s72
  s_cselect_b32 s70, s71, s70
  v_mfma_f32_16x16x32_bf16 v[20:23], v[148:151], v[224:227], v[20:23]
  v_add_f32 v49, v49, v53
  v_mul_f32 v48, s45, v48
  s_waitcnt vmcnt(17)
  s_barrier
  v_mfma_f32_32x32x16_bf16 v[4:19], v[152:155], a[84:87], v[4:19]
  ds_read_b64_tr_b16 v[148:149], v24 offset:32768
  ds_read_b64_tr_b16 v[150:151], v24 offset:33280
  buffer_load_dwordx4 v232, s[8:11], s70 offen offset:0 lds
  v_mul_f32 v50, v48, v48
  v_mfma_f32_16x16x32_bf16 v[20:23], v[152:155], v[224:227], v[20:23]
  v_fma_f32 v49, v49, s45, -v50
  v_max_f32 v49, 0, v49
  s_waitcnt lgkmcnt(6)
  v_mfma_f32_32x32x16_bf16 v[4:19], v[132:135], v[92:95], v[4:19]
  ds_read_b64_tr_b16 v[152:153], v25 offset:34816
  ds_read_b64_tr_b16 v[154:155], v25 offset:35328
  buffer_load_dwordx4 v233, s[8:11], s70 offen offset:1024 lds
  v_mfma_f32_16x16x32_bf16 v[20:23], v[132:135], v[224:227], v[20:23]
  v_add_f32 v50, s46, v49
  v_mfma_f32_32x32x16_bf16 v[4:19], v[136:139], a[88:91], v[4:19]
  ds_read_b64_tr_b16 v[132:133], v24 offset:36864
  ds_read_b64_tr_b16 v[134:135], v24 offset:37376
  buffer_load_dwordx4 v234, s[8:11], s70 offen offset:2048 lds
  v_xor_b32 v156, s67, v231
  v_mfma_f32_16x16x32_bf16 v[20:23], v[136:139], v[224:227], v[20:23]
  v_xor_b32 v157, 64, v156
  v_add_u32 v156, s66, v156
  s_waitcnt lgkmcnt(6)
  v_mfma_f32_32x32x16_bf16 v[4:19], v[140:143], v[96:99], v[4:19]
  ds_read_b64_tr_b16 v[136:137], v25 offset:38912
  ds_read_b64_tr_b16 v[138:139], v25 offset:39424
  buffer_load_dwordx4 v235, s[8:11], s70 offen offset:3072 lds
  v_add_u32 v157, s66, v157
  v_mfma_f32_16x16x32_bf16 v[20:23], v[140:143], v[224:227], v[20:23]
  s_waitcnt vmcnt(19)
  ds_read_b64_tr_b16 a[192:193], v156 offset:0
  ds_read_b64_tr_b16 a[194:195], v156 offset:1024
  v_mfma_f32_32x32x16_bf16 v[4:19], v[144:147], a[92:95], v[4:19]
  ds_read_b64_tr_b16 v[140:141], v24 offset:40960
  ds_read_b64_tr_b16 v[142:143], v24 offset:41472
  s_add_u32 m0, s76, 12288
  s_add_u32 s70, s70, 114688
  s_cmp_eq_u32 s70, s72
  s_cselect_b32 s70, s71, s70
  v_mfma_f32_16x16x32_bf16 v[20:23], v[144:147], v[224:227], v[20:23]
  ds_read_b64_tr_b16 a[196:197], v157 offset:0
  ds_read_b64_tr_b16 a[198:199], v157 offset:1024
  s_waitcnt lgkmcnt(10)
  v_mfma_f32_32x32x16_bf16 v[4:19], v[148:151], v[100:103], v[4:19]
  ds_read_b64_tr_b16 v[144:145], v25 offset:43008
  ds_read_b64_tr_b16 v[146:147], v25 offset:43520
  buffer_load_dwordx4 v232, s[8:11], s70 offen offset:0 lds
  v_mfma_f32_16x16x32_bf16 v[20:23], v[148:151], v[224:227], v[20:23]
  v_rsq_f32 v50, v50
  v_add_f32 v40, v40, v42
  s_barrier
  v_mfma_f32_32x32x16_bf16 v[4:19], v[152:155], a[96:99], v[4:19]
  ds_read_b64_tr_b16 v[148:149], v24 offset:45056
  ds_read_b64_tr_b16 v[150:151], v24 offset:45568
  buffer_load_dwordx4 v233, s[8:11], s70 offen offset:1024 lds
  v_mfma_f32_16x16x32_bf16 v[20:23], v[152:155], v[224:227], v[20:23]
  v_add_f32 v41, v41, v43
  v_add_f32 v44, v44, v46
  s_waitcnt lgkmcnt(10)
  v_mfma_f32_32x32x16_bf16 v[4:19], v[132:135], v[104:107], v[4:19]
  ds_read_b64_tr_b16 v[152:153], v25 offset:47104
  ds_read_b64_tr_b16 v[154:155], v25 offset:47616
  buffer_load_dwordx4 v234, s[8:11], s70 offen offset:2048 lds
  v_add_f32 v45, v45, v47
  v_mfma_f32_16x16x32_bf16 v[20:23], v[132:135], v[224:227], v[20:23]
  v_add_f32 v40, v40, v44
  v_add_f32 v41, v41, v45
  v_mfma_f32_32x32x16_bf16 v[4:19], v[136:139], a[100:103], v[4:19]
  ds_read_b64_tr_b16 v[132:133], v24 offset:49152
  ds_read_b64_tr_b16 v[134:135], v24 offset:49664
  buffer_load_dwordx4 v235, s[8:11], s70 offen offset:3072 lds
  v_mfma_f32_16x16x32_bf16 v[20:23], v[136:139], v[224:227], v[20:23]
  v_mul_f32 v40, s45, v40
  v_mul_f32 v42, v40, v40
  s_waitcnt lgkmcnt(6)
  v_mfma_f32_32x32x16_bf16 v[4:19], v[140:143], v[108:111], v[4:19]
  ds_read_b64_tr_b16 v[136:137], v25 offset:51200
  ds_read_b64_tr_b16 v[138:139], v25 offset:51712
  s_add_u32 m0, s51, 69632
  s_add_u32 s39, s74, 0
  s_and_b32 s39, s39, 0x7ffff
  v_fma_f32 v41, v41, s45, -v42
  v_mfma_f32_16x16x32_bf16 v[20:23], v[140:143], v[224:227], v[20:23]
  v_max_f32 v41, 0, v41
  v_add_f32 v42, s46, v41
  v_mfma_f32_32x32x16_bf16 v[4:19], v[144:147], a[104:107], v[4:19]
  ds_read_b64_tr_b16 v[140:141], v24 offset:53248
  ds_read_b64_tr_b16 v[142:143], v24 offset:53760
  buffer_load_dwordx4 v236, s[4:7], s39 offen offset:0 lds
  v_mfma_f32_16x16x32_bf16 v[20:23], v[144:147], v[224:227], v[20:23]
  v_rsq_f32 v42, v42
  s_waitcnt lgkmcnt(6)
  v_mfma_f32_32x32x16_bf16 v[4:19], v[148:151], v[112:115], v[4:19]
  ds_read_b64_tr_b16 v[144:145], v25 offset:55296
  ds_read_b64_tr_b16 v[146:147], v25 offset:55808
  buffer_store_dwordx4 a[196:199], v222, s[60:63], s65 offen offset:1024 sc1
  v_mul_f32 v51, v48, v50
  v_mfma_f32_16x16x32_bf16 v[20:23], v[148:151], v[224:227], v[20:23]
  v_mul_f32 v43, v42, v42
  v_fma_f32 v43, v43, v41, s46
  v_mfma_f32_32x32x16_bf16 v[4:19], v[152:155], a[108:111], v[4:19]
  ds_read_b64_tr_b16 v[148:149], v24 offset:57344
  ds_read_b64_tr_b16 v[150:151], v24 offset:57856
  buffer_store_dwordx4 a[192:195], v222, s[60:63], s65 offen offset:0 sc1
  v_mfma_f32_16x16x32_bf16 v[20:23], v[152:155], v[224:227], v[20:23]
  v_rsq_f32 v43, v43
  s_waitcnt lgkmcnt(6)
  v_mfma_f32_32x32x16_bf16 v[4:19], v[132:135], v[116:119], v[4:19]
  ds_read_b64_tr_b16 v[152:153], v25 offset:59392
  ds_read_b64_tr_b16 v[154:155], v25 offset:59904
  buffer_load_dwordx4 v237, s[4:7], s39 offen offset:1024 lds
  v_sub_f32 v40, 0, v40
  v_mfma_f32_16x16x32_bf16 v[20:23], v[132:135], v[224:227], v[20:23]
  v_mul_f32 v42, v42, v43
  v_mfma_f32_32x32x16_bf16 v[4:19], v[136:139], a[112:115], v[4:19]
  ds_read_b64_tr_b16 v[132:133], v24 offset:61440
  ds_read_b64_tr_b16 v[134:135], v24 offset:61952
  buffer_load_dwordx4 v238, s[4:7], s39 offen offset:2048 lds
  v_mfma_f32_16x16x32_bf16 v[20:23], v[136:139], v[224:227], v[20:23]
  v_rcp_f32 v41, v42
  v_mul_f32 v44, s47, v42
  s_waitcnt lgkmcnt(6)
  v_mfma_f32_32x32x16_bf16 v[4:19], v[140:143], v[120:123], v[4:19]
  ds_read_b64_tr_b16 v[136:137], v25 offset:63488
  ds_read_b64_tr_b16 v[138:139], v25 offset:64000
  buffer_load_dwordx4 v239, s[4:7], s39 offen offset:3072 lds
  v_mfma_f32_16x16x32_bf16 v[20:23], v[140:143], v[224:227], v[20:23]
  v_mul_f32 v45, v42, v42
  v_mul_f32 v45, v45, v42
  v_mfma_f32_32x32x16_bf16 v[4:19], v[144:147], a[116:119], v[4:19]
  s_add_u32 m0, s51, 86016
  s_add_u32 s39, s74, 131072
  s_and_b32 s39, s39, 0x7ffff
  v_mul_f32 v45, s48, v45
  v_mfma_f32_16x16x32_bf16 v[20:23], v[144:147], v[224:227], v[20:23]
  v_fma_f32 v188, v188, v50, -v51
  v_fma_f32 v189, v189, v50, -v51
  s_waitcnt lgkmcnt(4)
  v_mfma_f32_32x32x16_bf16 v[4:19], v[148:151], v[124:127], v[4:19]
  buffer_load_dwordx4 v236, s[4:7], s39 offen offset:0 lds
  v_mfma_f32_16x16x32_bf16 v[20:23], v[148:151], v[224:227], v[20:23]
  v_fma_f32 v190, v190, v50, -v51
  v_fma_f32 v191, v191, v50, -v51
  v_mfma_f32_32x32x16_bf16 v[4:19], v[152:155], a[120:123], v[4:19]
  buffer_load_dwordx4 v237, s[4:7], s39 offen offset:1024 lds
  v_fma_f32 v192, v192, v50, -v51
  v_mfma_f32_16x16x32_bf16 v[20:23], v[152:155], v[224:227], v[20:23]
  v_fma_f32 v193, v193, v50, -v51
  v_fma_f32 v194, v194, v50, -v51
  s_waitcnt lgkmcnt(0)
  v_mfma_f32_32x32x16_bf16 v[4:19], v[132:135], v[128:131], v[4:19]
  buffer_load_dwordx4 v238, s[4:7], s39 offen offset:2048 lds
  v_mfma_f32_16x16x32_bf16 v[20:23], v[132:135], v[224:227], v[20:23]
  v_fma_f32 v195, v195, v50, -v51
  v_fma_f32 v196, v196, v50, -v51
  v_mfma_f32_32x32x16_bf16 v[4:19], v[136:139], a[124:127], v[4:19]
  buffer_load_dwordx4 v239, s[4:7], s39 offen offset:3072 lds
  v_fma_f32 v197, v197, v50, -v51
  v_mfma_f32_16x16x32_bf16 v[20:23], v[136:139], v[224:227], v[20:23]
  v_fma_f32 v198, v198, v50, -v51
  v_fma_f32 v199, v199, v50, -v51
  v_fma_f32 v200, v200, v50, -v51
  v_fma_f32 v201, v201, v50, -v51
  v_fma_f32 v202, v202, v50, -v51
  v_fma_f32 v203, v203, v50, -v51
  v_cvt_pk_bf16_f32 v156, v188, v189
  v_cvt_pk_bf16_f32 v157, v190, v191
  v_cvt_pk_bf16_f32 v158, v192, v193
  v_cvt_pk_bf16_f32 v159, v194, v195
  v_cvt_pk_bf16_f32 v160, v196, v197
  v_cvt_pk_bf16_f32 v161, v198, v199
  v_cvt_pk_bf16_f32 v162, v200, v201
  v_cvt_pk_bf16_f32 v163, v202, v203
  ds_write_b64 v29, v[156:157] offset:0
  ds_write_b64 v29, v[158:159] offset:16
  ds_write_b64 v29, v[160:161] offset:32
  ds_write_b64 v29, v[162:163] offset:48
  ds_read_b64_tr_b16 v[156:157], v30 offset:0
  ds_read_b64_tr_b16 v[158:159], v30 offset:288
  ds_read_b64_tr_b16 v[160:161], v30 offset:1152
  ds_read_b64_tr_b16 v[162:163], v30 offset:1440
  s_waitcnt lgkmcnt(2)
  ds_write_b128 v31, v[156:159] offset:0
  s_waitcnt lgkmcnt(1)
  ds_write_b128 v31, v[160:163] offset:32
  s_waitcnt vmcnt(27)
  ds_read_b64_tr_b16 a[0:1], v248 offset:11776
  ds_read_b64_tr_b16 a[2:3], v248 offset:12800
  ds_read_b64_tr_b16 a[128:129], v249 offset:11776
  ds_read_b64_tr_b16 a[130:131], v249 offset:12800
  ds_read_b64_tr_b16 a[4:5], v248 offset:13824
  ds_read_b64_tr_b16 a[6:7], v248 offset:14848
  ds_read_b64_tr_b16 a[132:133], v249 offset:13824
  ds_read_b64_tr_b16 a[134:135], v249 offset:14848
  s_waitcnt vmcnt(22)
  ds_read_b64_tr_b16 a[8:9], v2 offset:0
  ds_read_b64_tr_b16 a[10:11], v2 offset:1024
  ds_read_b64_tr_b16 a[136:137], v3 offset:0
  ds_read_b64_tr_b16 a[138:139], v3 offset:1024
  ds_read_b64_tr_b16 a[12:13], v2 offset:2048
  ds_read_b64_tr_b16 a[14:15], v2 offset:3072
  ds_read_b64_tr_b16 a[140:141], v3 offset:2048
  ds_read_b64_tr_b16 a[142:143], v3 offset:3072
  s_waitcnt vmcnt(18)
  ds_read_b64_tr_b16 a[16:17], v2 offset:4096
  ds_read_b64_tr_b16 a[18:19], v2 offset:5120
  ds_read_b64_tr_b16 a[144:145], v3 offset:4096
  ds_read_b64_tr_b16 a[146:147], v3 offset:5120
  ds_read_b64_tr_b16 a[20:21], v2 offset:6144
  ds_read_b64_tr_b16 a[22:23], v2 offset:7168
  ds_read_b64_tr_b16 a[148:149], v3 offset:6144
  ds_read_b64_tr_b16 a[150:151], v3 offset:7168
  s_waitcnt vmcnt(14)
  ds_read_b64_tr_b16 a[24:25], v2 offset:8192
  ds_read_b64_tr_b16 a[26:27], v2 offset:9216
  ds_read_b64_tr_b16 a[152:153], v3 offset:8192
  ds_read_b64_tr_b16 a[154:155], v3 offset:9216
  ds_read_b64_tr_b16 a[28:29], v2 offset:10240
  ds_read_b64_tr_b16 a[30:31], v2 offset:11264
  ds_read_b64_tr_b16 a[156:157], v3 offset:10240
  ds_read_b64_tr_b16 a[158:159], v3 offset:11264
  s_mov_b32 exec_lo, 0x01010101
  s_mov_b32 exec_hi, 0x01010101
  ds_write_b128 v228, v[20:23]
  s_mov_b64 exec, -1
  ds_read_b128 v[68:71], v223 offset:0
  ds_read_b128 v[72:75], v223 offset:32
  ds_read_b128 v[76:79], v223 offset:64
  ds_read_b128 v[80:83], v223 offset:96
  v_lshrrev_b32 v24, 3, v255
  v_and_b32 v92, 3, v255
  v_lshlrev_b32 v92, 4, v92
  v_mul_u32_u24 v24, 80, v24
  v_bfe_u32 v93, v255, 2, 1
  v_mul_u32_u24 v93, 5088, v93
  s_mul_i32 s38, s42, 1280
  s_mul_i32 s37, s43, 2544
  s_add_u32 s38, s38, s37
  s_add_u32 s38, s38, 135168
  v_add_u32 v24, v24, v93
  v_add3_u32 v24, v24, v92, s38
  v_readfirstlane_b32 s20, v244
  v_readfirstlane_b32 s21, v245
  s_mov_b32 s36, s20
  s_cmp_lg_u32 s36, 0
  s_cbranch_scc1 NK_2
  s_mov_b32 s34, 0
NL_3:
  global_load_dwordx2 v[244:245], v1, s[30:31] sc1
  s_add_u32 s34, s34, 1
  s_waitcnt vmcnt(0)
  v_readfirstlane_b32 s20, v244
  v_readfirstlane_b32 s21, v245
  s_mov_b32 s36, s20
  s_cmp_gt_u32 s34, 0x40000
  s_cbranch_scc1 NK_2
  s_cmp_eq_u32 s36, 0
  s_cbranch_scc1 NL_3
NK_2:
  s_waitcnt vmcnt(10)
  ds_read_b64_tr_b16 a[32:33], v2 offset:12288
  ds_read_b64_tr_b16 a[34:35], v2 offset:13312
  ds_read_b64_tr_b16 a[160:161], v3 offset:12288
  ds_read_b64_tr_b16 a[162:163], v3 offset:13312
  ds_read_b64_tr_b16 a[36:37], v2 offset:14336
  ds_read_b64_tr_b16 a[38:39], v2 offset:15360
  ds_read_b64_tr_b16 a[164:165], v3 offset:14336
  ds_read_b64_tr_b16 a[166:167], v3 offset:15360
  s_waitcnt lgkmcnt(0)
  s_barrier
  ds_read_b128 v[92:95], v24
  ds_read_b128 v[96:99], v24 offset:640
  v_pk_fma_f32 v[4:5], v[68:69], v[40:41], v[4:5] op_sel:[0,0,0] op_sel_hi:[1,0,1]
  v_pk_fma_f32 v[6:7], v[70:71], v[40:41], v[6:7] op_sel:[0,0,0] op_sel_hi:[1,0,1]
  v_pk_fma_f32 v[8:9], v[72:73], v[40:41], v[8:9] op_sel:[0,0,0] op_sel_hi:[1,0,1]
  s_add_u32 m0, s51, 102400
  s_add_u32 s39, s74, 262144
  s_and_b32 s39, s39, 0x7ffff
  v_pk_fma_f32 v[10:11], v[74:75], v[40:41], v[10:11] op_sel:[0,0,0] op_sel_hi:[1,0,1]
  v_pk_mul_f32 v[132:133], v[4:5], v[4:5]
  v_pk_mul_f32 v[134:135], v[6:7], v[6:7]
  buffer_load_dwordx4 v236, s[4:7], s39 offen offset:0 lds
  v_pk_mul_f32 v[136:137], v[8:9], v[8:9]
  v_pk_mul_f32 v[138:139], v[10:11], v[10:11]
  v_pk_fma_f32 v[132:133], v[132:133], v[44:45], v[44:45] op_sel:[0,1,0] op_sel_hi:[1,1,0]
  buffer_load_dwordx4 v237, s[4:7], s39 offen offset:1024 lds
  v_pk_fma_f32 v[134:135], v[134:135], v[44:45], v[44:45] op_sel:[0,1,0] op_sel_hi:[1,1,0]
  v_pk_fma_f32 v[136:137], v[136:137], v[44:45], v[44:45] op_sel:[0,1,0] op_sel_hi:[1,1,0]
  v_pk_fma_f32 v[138:139], v[138:139], v[44:45], v[44:45] op_sel:[0,1,0] op_sel_hi:[1,1,0]
  buffer_load_dwordx4 v238, s[4:7], s39 offen offset:2048 lds
  v_pk_mul_f32 v[132:133], v[132:133], v[4:5]
  v_pk_mul_f32 v[134:135], v[134:135], v[6:7]
  v_pk_mul_f32 v[136:137], v[136:137], v[8:9]
  buffer_load_dwordx4 v239, s[4:7], s39 offen offset:3072 lds
  v_pk_mul_f32 v[138:139], v[138:139], v[10:11]
  v_exp_f32 v132, v132
  v_exp_f32 v133, v133
  s_add_u32 m0, s51, 118784
  s_add_u32 s39, s74, 393216
  s_and_b32 s39, s39, 0x7ffff
  v_exp_f32 v134, v134
  v_exp_f32 v135, v135
  v_exp_f32 v136, v136
  buffer_load_dwordx4 v236, s[4:7], s39 offen offset:0 lds
  v_exp_f32 v137, v137
  v_exp_f32 v138, v138
  v_exp_f32 v139, v139
  buffer_load_dwordx4 v237, s[4:7], s39 offen offset:1024 lds
  v_pk_fma_f32 v[132:133], v[132:133], v[40:41], v[40:41] op_sel:[0,1,1] op_sel_hi:[1,1,1]
  v_pk_fma_f32 v[134:135], v[134:135], v[40:41], v[40:41] op_sel:[0,1,1] op_sel_hi:[1,1,1]
  v_pk_fma_f32 v[136:137], v[136:137], v[40:41], v[40:41] op_sel:[0,1,1] op_sel_hi:[1,1,1]
  buffer_load_dwordx4 v238, s[4:7], s39 offen offset:2048 lds
  v_pk_fma_f32 v[138:139], v[138:139], v[40:41], v[40:41] op_sel:[0,1,1] op_sel_hi:[1,1,1]
  v_rcp_f32 v132, v132
  v_rcp_f32 v133, v133
  buffer_load_dwordx4 v239, s[4:7], s39 offen offset:3072 lds
  v_rcp_f32 v134, v134
  v_rcp_f32 v135, v135
  v_rcp_f32 v136, v136
  s_waitcnt lgkmcnt(1)
  buffer_store_dwordx4 v[92:95], v222, s[60:63], s26 offen sc1
  v_rcp_f32 v137, v137
  v_rcp_f32 v138, v138
  v_rcp_f32 v139, v139
  s_waitcnt lgkmcnt(0)
  buffer_store_dwordx4 v[96:99], v222, s[60:63], s26 offen offset:1024 sc1
  v_pk_mul_f32 v[132:133], v[132:133], v[4:5]
  v_pk_mul_f32 v[134:135], v[134:135], v[6:7]
  v_pk_mul_f32 v[136:137], v[136:137], v[8:9]
  v_pk_mul_f32 v[138:139], v[138:139], v[10:11]
  v_cvt_pk_bf16_f32 v84, v132, v133
  v_cvt_pk_bf16_f32 v85, v134, v135
  v_cvt_pk_bf16_f32 v86, v136, v137
  v_cvt_pk_bf16_f32 v87, v138, v139
  buffer_store_dwordx4 v[84:87], v222, s[60:63], s23 offen sc1
  v_pk_fma_f32 v[12:13], v[76:77], v[40:41], v[12:13] op_sel:[0,0,0] op_sel_hi:[1,0,1]
  v_pk_fma_f32 v[14:15], v[78:79], v[40:41], v[14:15] op_sel:[0,0,0] op_sel_hi:[1,0,1]
  v_pk_fma_f32 v[16:17], v[80:81], v[40:41], v[16:17] op_sel:[0,0,0] op_sel_hi:[1,0,1]
  v_pk_fma_f32 v[18:19], v[82:83], v[40:41], v[18:19] op_sel:[0,0,0] op_sel_hi:[1,0,1]
  v_pk_mul_f32 v[132:133], v[12:13], v[12:13]
  v_pk_mul_f32 v[134:135], v[14:15], v[14:15]
  v_pk_mul_f32 v[136:137], v[16:17], v[16:17]
  v_pk_mul_f32 v[138:139], v[18:19], v[18:19]
  v_pk_fma_f32 v[132:133], v[132:133], v[44:45], v[44:45] op_sel:[0,1,0] op_sel_hi:[1,1,0]
  v_pk_fma_f32 v[134:135], v[134:135], v[44:45], v[44:45] op_sel:[0,1,0] op_sel_hi:[1,1,0]
  v_pk_fma_f32 v[136:137], v[136:137], v[44:45], v[44:45] op_sel:[0,1,0] op_sel_hi:[1,1,0]
  v_pk_fma_f32 v[138:139], v[138:139], v[44:45], v[44:45] op_sel:[0,1,0] op_sel_hi:[1,1,0]
  v_pk_mul_f32 v[132:133], v[132:133], v[12:13]
  v_pk_mul_f32 v[134:135], v[134:135], v[14:15]
  v_pk_mul_f32 v[136:137], v[136:137], v[16:17]
  v_pk_mul_f32 v[138:139], v[138:139], v[18:19]
  v_exp_f32 v132, v132
  v_exp_f32 v133, v133
  v_exp_f32 v134, v134
  v_exp_f32 v135, v135
  v_exp_f32 v136, v136
  v_exp_f32 v137, v137
  v_exp_f32 v138, v138
  v_exp_f32 v139, v139
  v_pk_fma_f32 v[132:133], v[132:133], v[40:41], v[40:41] op_sel:[0,1,1] op_sel_hi:[1,1,1]
  v_pk_fma_f32 v[134:135], v[134:135], v[40:41], v[40:41] op_sel:[0,1,1] op_sel_hi:[1,1,1]
  v_pk_fma_f32 v[136:137], v[136:137], v[40:41], v[40:41] op_sel:[0,1,1] op_sel_hi:[1,1,1]
  v_pk_fma_f32 v[138:139], v[138:139], v[40:41], v[40:41] op_sel:[0,1,1] op_sel_hi:[1,1,1]
  v_rcp_f32 v132, v132
  v_rcp_f32 v133, v133
  v_rcp_f32 v134, v134
  v_rcp_f32 v135, v135
  v_rcp_f32 v136, v136
  v_rcp_f32 v137, v137
  v_rcp_f32 v138, v138
  v_rcp_f32 v139, v139
  v_pk_mul_f32 v[132:133], v[132:133], v[12:13]
  v_pk_mul_f32 v[134:135], v[134:135], v[14:15]
  v_pk_mul_f32 v[136:137], v[136:137], v[16:17]
  v_pk_mul_f32 v[138:139], v[138:139], v[18:19]
  v_cvt_pk_bf16_f32 v88, v132, v133
  v_cvt_pk_bf16_f32 v89, v134, v135
  v_cvt_pk_bf16_f32 v90, v136, v137
  v_cvt_pk_bf16_f32 v91, v138, v139
  buffer_store_dwordx4 v[88:91], v222, s[60:63], s23 offen offset:1024 sc1
  v_pk_mul_f32 v[10:11], v[64:65], v[38:39] op_sel:[0,0] op_sel_hi:[0,1]
  s_mul_i32 s36, s43, 27648
  s_lshl_b32 s37, s42, 8
  v_pk_mul_f32 v[8:9], v[62:63], v[38:39] op_sel:[0,0] op_sel_hi:[0,1]
  s_add_u32 s37, s37, s36
  v_pk_fma_f32 v[64:65], v[64:65], v[38:39], v[10:11] op_sel:[1,1,0] op_sel_hi:[1,0,1] neg_lo:[1,0,0]
  v_lshl_add_u32 v4, v255, 2, s37
  v_pk_fma_f32 v[62:63], v[62:63], v[38:39], v[8:9] op_sel:[1,1,0] op_sel_hi:[1,0,1] neg_lo:[1,0,0]
  v_xor_b32 v5, 64, v4
  v_cvt_pk_f16_f32 v13, v64, v65
  v_xor_b32 v6, 128, v4
  v_cvt_pk_f16_f32 v12, v62, v63
  v_xor_b32 v7, 192, v4
  v_accvgpr_write_b32 a239, v13
  ds_write2st64_b32 v4, a200, a201 offset0:0 offset1:2
  v_accvgpr_write_b32 a240, v12
  ds_write2st64_b32 v5, a202, a203 offset0:4 offset1:6
  v_pk_mul_f32 v[10:11], v[64:65], v[38:39] op_sel:[0,0] op_sel_hi:[0,1]
  ds_write2st64_b32 v6, a204, a205 offset0:8 offset1:10
  v_pk_mul_f32 v[8:9], v[62:63], v[38:39] op_sel:[0,0] op_sel_hi:[0,1]
  ds_write2st64_b32 v7, a206, a207 offset0:12 offset1:14
  v_pk_fma_f32 v[64:65], v[64:65], v[38:39], v[10:11] op_sel:[1,1,0] op_sel_hi:[1,0,1] neg_lo:[1,0,0]
  ds_write2st64_b32 v4, a208, a209 offset0:16 offset1:18
  v_pk_fma_f32 v[62:63], v[62:63], v[38:39], v[8:9] op_sel:[1,1,0] op_sel_hi:[1,0,1] neg_lo:[1,0,0]
  ds_write2st64_b32 v5, a210, a211 offset0:20 offset1:22
  v_cvt_pk_f16_f32 v13, v64, v65
  ds_write2st64_b32 v6, a212, a213 offset0:24 offset1:26
  v_cvt_pk_f16_f32 v12, v62, v63
  ds_write2st64_b32 v7, a214, a215 offset0:28 offset1:30
  v_accvgpr_write_b32 a241, v13
  ds_write2st64_b32 v4, a216, a217 offset0:32 offset1:34
  v_accvgpr_write_b32 a242, v12
  ds_write2st64_b32 v5, a218, a219 offset0:36 offset1:38
  ds_write2st64_b32 v6, a220, a221 offset0:40 offset1:42
  v_pk_mul_f32 v[10:11], v[64:65], v[38:39] op_sel:[0,0] op_sel_hi:[0,1]
  ds_write2st64_b32 v7, a222, a223 offset0:44 offset1:46
  v_pk_mul_f32 v[8:9], v[62:63], v[38:39] op_sel:[0,0] op_sel_hi:[0,1]
  ds_write2st64_b32 v4, a224, a225 offset0:48 offset1:50
  v_pk_fma_f32 v[64:65], v[64:65], v[38:39], v[10:11] op_sel:[1,1,0] op_sel_hi:[1,0,1] neg_lo:[1,0,0]
  ds_write2st64_b32 v5, a226, a227 offset0:52 offset1:54
  v_pk_fma_f32 v[62:63], v[62:63], v[38:39], v[8:9] op_sel:[1,1,0] op_sel_hi:[1,0,1] neg_lo:[1,0,0]
  ds_write2st64_b32 v6, a228, a229 offset0:56 offset1:58
  v_cvt_pk_f16_f32 v13, v64, v65
  ds_write2st64_b32 v7, a230, a231 offset0:60 offset1:62
  v_cvt_pk_f16_f32 v12, v62, v63
  ds_write2st64_b32 v4, a232, a233 offset0:64 offset1:66
  v_accvgpr_write_b32 a243, v13
  ds_write2st64_b32 v5, a234, a235 offset0:68 offset1:70
  v_accvgpr_write_b32 a244, v12
  ds_write2st64_b32 v6, a236, a237 offset0:72 offset1:74
  v_pk_mul_f32 v[10:11], v[64:65], v[38:39] op_sel:[0,0] op_sel_hi:[0,1]
  v_and_b32 v181, 15, v255
  v_pk_mul_f32 v[8:9], v[62:63], v[38:39] op_sel:[0,0] op_sel_hi:[0,1]
  v_lshrrev_b32 v182, 4, v255
  v_pk_fma_f32 v[64:65], v[64:65], v[38:39], v[10:11] op_sel:[1,1,0] op_sel_hi:[1,0,1] neg_lo:[1,0,0]
  v_lshlrev_b32 v183, 9, v181
  v_pk_fma_f32 v[62:63], v[62:63], v[38:39], v[8:9] op_sel:[1,1,0] op_sel_hi:[1,0,1] neg_lo:[1,0,0]
  v_lshl_add_u32 v183, v182, 4, v183
  v_cvt_pk_f16_f32 v13, v64, v65
  v_add_u32 v183, s36, v183
  v_cvt_pk_f16_f32 v12, v62, v63
  v_lshlrev_b32 v184, 5, v181
  v_accvgpr_write_b32 a245, v13
  v_and_b32 v1, 192, v184
  v_add_u32 v1, v1, v183
  v_accvgpr_write_b32 a246, v12
  v_add_u32 v184, 704, v184
  v_pk_mul_f32 v[10:11], v[64:65], v[38:39] op_sel:[0,0] op_sel_hi:[0,1]
  v_and_b32 v2, 192, v184
  v_pk_mul_f32 v[8:9], v[62:63], v[38:39] op_sel:[0,0] op_sel_hi:[0,1]
  s_lshl_b32 s34, s42, 13
  v_pk_fma_f32 v[64:65], v[64:65], v[38:39], v[10:11] op_sel:[1,1,0] op_sel_hi:[1,0,1] neg_lo:[1,0,0]
  v_add3_u32 v2, v2, v183, s34
  v_pk_fma_f32 v[62:63], v[62:63], v[38:39], v[8:9] op_sel:[1,1,0] op_sel_hi:[1,0,1] neg_lo:[1,0,0]
  s_lshl_b32 s34, s42, 4
  v_cvt_pk_f16_f32 v13, v64, v65
  v_add_u32 v181, s34, v181
  v_cvt_pk_f16_f32 v12, v62, v63
  s_mul_i32 s35, s43, 3088
  v_accvgpr_write_b32 a247, v13
  s_add_u32 s35, s35, 152080
  v_accvgpr_write_b32 a248, v12
  v_max_u32 v183, 1, v182
  v_pk_mul_f32 v[10:11], v[64:65], v[38:39] op_sel:[0,0] op_sel_hi:[0,1]
  v_sub_u32 v183, 6, v183
  v_pk_mul_f32 v[8:9], v[62:63], v[38:39] op_sel:[0,0] op_sel_hi:[0,1]
  v_lshlrev_b32 v183, v183, v181
  v_pk_fma_f32 v[64:65], v[64:65], v[38:39], v[10:11] op_sel:[1,1,0] op_sel_hi:[1,0,1] neg_lo:[1,0,0]
  v_cmp_gt_u32 vcc, 32, v255
  v_pk_fma_f32 v[62:63], v[62:63], v[38:39], v[8:9] op_sel:[1,1,0] op_sel_hi:[1,0,1] neg_lo:[1,0,0]
  v_lshlrev_b32 v184, 4, v182
  v_cvt_pk_f16_f32 v13, v64, v65
  v_lshlrev_b32 v185, 9, v182
  v_cvt_pk_f16_f32 v12, v62, v63
  v_cndmask_b32 v184, v185, v184, vcc
  v_add3_u32 v184, v184, v183, s35
  v_accvgpr_write_b32 a249, v13
  v_lshl_add_u32 v186, v181, 2, v185
  v_accvgpr_write_b32 a250, v12
  v_add_u32 v186, s35, v186
  v_pk_mul_f32 v[10:11], v[64:65], v[38:39] op_sel:[0,0] op_sel_hi:[0,1]
  v_cmp_gt_u32 vcc, 48, v255
  v_pk_mul_f32 v[8:9], v[62:63], v[38:39] op_sel:[0,0] op_sel_hi:[0,1]
  v_mov_b32 v185, 0x100
  v_pk_fma_f32 v[64:65], v[64:65], v[38:39], v[10:11] op_sel:[1,1,0] op_sel_hi:[1,0,1] neg_lo:[1,0,0]
  s_lshl_b32 s34, s42, 6
  v_pk_fma_f32 v[62:63], v[62:63], v[38:39], v[8:9] op_sel:[1,1,0] op_sel_hi:[1,0,1] neg_lo:[1,0,0]
  v_cndmask_b32 v185, v185, 8, vcc
  v_cvt_pk_f16_f32 v13, v64, v65
  v_add_u32 v185, v185, v184
  v_cvt_pk_f16_f32 v12, v62, v63
  v_xor_b32 v180, s34, v231
  v_accvgpr_write_b32 a251, v13
  v_add_u32 v180, 69632, v180
  v_accvgpr_write_b32 a252, v12
  s_lshr_b32 s38, s40, 1
  v_pk_mul_f32 v[10:11], v[64:65], v[38:39] op_sel:[0,0] op_sel_hi:[0,1]
  s_lshl_b32 s38, s38, 7
  v_pk_fma_f32 v[64:65], v[64:65], v[38:39], v[10:11] op_sel:[1,1,0] op_sel_hi:[1,0,1] neg_lo:[1,0,0]
  s_and_b32 s24, s40, 1
  v_cvt_pk_f16_f32 v13, v64, v65
  s_lshl3_add_u32 s38, s24, s38
  v_accvgpr_write_b32 a253, v13
  s_add_u32 s24, s38, s27
  ds_write2st64_b32 v7, a238, a239 offset0:76 offset1:78
  ds_write2st64_b32 v4, a240, a241 offset0:80 offset1:82
  ds_write2st64_b32 v5, a242, a243 offset0:84 offset1:86
  ds_write2st64_b32 v6, a244, a245 offset0:88 offset1:90
  ds_write2st64_b32 v7, a246, a247 offset0:92 offset1:94
  ds_write2st64_b32 v4, a248, a249 offset0:96 offset1:98
  ds_write2st64_b32 v5, a250, a251 offset0:100 offset1:102
  ds_write2st64_b32 v6, a252, a253 offset0:104 offset1:106
  s_waitcnt vmcnt(0)
  s_waitcnt lgkmcnt(0)
  s_barrier
  buffer_store_dwordx2 v[244:245], v243, s[60:63], s24 offen sc1
  s_lshl_b32 s38, s3, 3
  s_add_u32 s38, s38, s32
  buffer_store_dwordx2 v[244:245], v243, s[60:63], s38 offen sc1
  ds_read_b128 v[132:135], v2 offset:11264
  ds_read_b128 v[136:139], v1 offset:0
  ds_read_b128 v[140:143], v1 offset:8192
  v_xor_b32 v156, 64, v1
  v_xor_b32 v157, 64, v2
  v_xor_b32 v158, 128, v1
  v_xor_b32 v159, 128, v2
  v_xor_b32 v160, 192, v1
  v_xor_b32 v161, 192, v2
  v_mov_b32 v3, v180
  ds_read_b128 v[144:147], v157 offset:11264
  ds_read_b128 v[148:151], v156 offset:0
  ds_read_b128 v[152:155], v156 offset:8192
  ds_read_b64_tr_b16 v[4:5], v3 offset:0
  ds_read_b64_tr_b16 v[6:7], v3 offset:1024
  ds_read_b64_tr_b16 v[8:9], v3 offset:2048
  s_waitcnt lgkmcnt(7)
  v_mfma_f32_16x16x32_f16 v[172:175], v[136:139], v[132:135], 0
  s_add_u32 m0, s75, 0
  s_add_u32 s70, s70, 114688
  s_cmp_eq_u32 s70, s72
  s_cselect_b32 s70, s71, s70
  v_mfma_f32_16x16x32_bf16 a[248:251], a[0:3], v[224:227], 0
  s_waitcnt lgkmcnt(6)
  v_mfma_f32_16x16x32_f16 v[176:179], v[140:143], v[132:135], 0
  buffer_load_dwordx4 v232, s[8:11], s70 offen offset:0 lds
  v_mfma_f32_16x16x32_bf16 a[252:255], a[128:131], v[224:227], 0
  ds_read_b128 v[132:135], v159 offset:11264
  ds_read_b128 v[136:139], v158 offset:0
  ds_read_b128 v[140:143], v158 offset:8192
  v_mfma_f32_16x16x32_bf16 a[248:251], a[4:7], v[224:227], a[248:251]
  ds_read_b64_tr_b16 v[10:11], v3 offset:3072
  ds_read_b64_tr_b16 v[12:13], v3 offset:4096
  ds_read_b64_tr_b16 v[14:15], v3 offset:5120
  s_waitcnt lgkmcnt(10)
  v_mfma_f32_16x16x32_f16 v[172:175], v[148:151], v[144:147], v[172:175]
  buffer_load_dwordx4 v233, s[8:11], s70 offen offset:1024 lds
  v_mfma_f32_16x16x32_bf16 a[252:255], a[132:135], v[224:227], a[252:255]
  s_waitcnt lgkmcnt(9)
  v_mfma_f32_16x16x32_f16 v[176:179], v[152:155], v[144:147], v[176:179]
  buffer_load_dwordx4 v234, s[8:11], s70 offen offset:2048 lds
  v_mfma_f32_16x16x32_bf16 a[248:251], a[8:11], v[224:227], a[248:251]
  ds_read_b128 v[144:147], v161 offset:11264
  ds_read_b128 v[148:151], v160 offset:0
  ds_read_b128 v[152:155], v160 offset:8192
  v_mfma_f32_16x16x32_bf16 a[252:255], a[136:139], v[224:227], a[252:255]
  ds_read_b64_tr_b16 v[16:17], v3 offset:6144
  ds_read_b64_tr_b16 v[18:19], v3 offset:7168
  ds_read_b64_tr_b16 v[20:21], v3 offset:8192
  s_waitcnt lgkmcnt(10)
  v_mfma_f32_16x16x32_f16 v[172:175], v[136:139], v[132:135], v[172:175]
  buffer_load_dwordx4 v235, s[8:11], s70 offen offset:3072 lds
  v_mfma_f32_16x16x32_bf16 a[248:251], a[12:15], v[224:227], a[248:251]
  s_waitcnt lgkmcnt(9)
  v_mfma_f32_16x16x32_f16 v[176:179], v[140:143], v[132:135], v[176:179]
  v_mfma_f32_16x16x32_bf16 a[252:255], a[140:143], v[224:227], a[252:255]
  ds_read_b128 v[132:135], v2 offset:11520
  ds_read_b128 v[136:139], v1 offset:256
  ds_read_b128 v[140:143], v1 offset:8448
  v_mfma_f32_16x16x32_bf16 a[248:251], a[16:19], v[224:227], a[248:251]
  ds_read_b64_tr_b16 v[22:23], v3 offset:9216
  ds_read_b64_tr_b16 v[24:25], v3 offset:10240
  ds_read_b64_tr_b16 v[26:27], v3 offset:11264
  s_waitcnt lgkmcnt(10)
  v_mfma_f32_16x16x32_f16 v[172:175], v[148:151], v[144:147], v[172:175]
  v_mfma_f32_16x16x32_bf16 a[252:255], a[144:147], v[224:227], a[252:255]
  s_waitcnt lgkmcnt(9)
  v_mfma_f32_16x16x32_f16 v[176:179], v[152:155], v[144:147], v[176:179]
  v_mfma_f32_16x16x32_bf16 a[248:251], a[20:23], v[224:227], a[248:251]
  ds_read_b128 v[144:147], v157 offset:11520
  ds_read_b128 v[148:151], v156 offset:256
  ds_read_b128 v[152:155], v156 offset:8448
  v_mfma_f32_16x16x32_bf16 a[252:255], a[148:151], v[224:227], a[252:255]
  ds_read_b64_tr_b16 v[28:29], v3 offset:12288
  ds_read_b64_tr_b16 v[30:31], v3 offset:13312
  ds_read_b64_tr_b16 v[32:33], v3 offset:14336
  s_waitcnt lgkmcnt(10)
  v_mfma_f32_16x16x32_f16 v[172:175], v[136:139], v[132:135], v[172:175]
  v_mfma_f32_16x16x32_bf16 a[248:251], a[24:27], v[224:227], a[248:251]
  s_waitcnt lgkmcnt(9)
  v_mfma_f32_16x16x32_f16 v[176:179], v[140:143], v[132:135], v[176:179]
  v_mfma_f32_16x16x32_bf16 a[252:255], a[152:155], v[224:227], a[252:255]
  ds_read_b128 v[132:135], v159 offset:11520
  ds_read_b128 v[136:139], v158 offset:256
  ds_read_b128 v[140:143], v158 offset:8448
  v_mfma_f32_16x16x32_bf16 a[248:251], a[28:31], v[224:227], a[248:251]
  ds_read_b64_tr_b16 v[34:35], v3 offset:15360
  ds_read_b64_tr_b16 v[36:37], v3 offset:16384
  ds_read_b64_tr_b16 v[38:39], v3 offset:17408
  s_waitcnt lgkmcnt(10)
  v_mfma_f32_16x16x32_f16 v[172:175], v[148:151], v[144:147], v[172:175]
  v_mfma_f32_16x16x32_bf16 a[252:255], a[156:159], v[224:227], a[252:255]
  s_waitcnt lgkmcnt(9)
  v_mfma_f32_16x16x32_f16 v[176:179], v[152:155], v[144:147], v[176:179]
  v_mfma_f32_16x16x32_bf16 a[248:251], a[32:35], v[224:227], a[248:251]
  ds_read_b128 v[144:147], v161 offset:11520
  ds_read_b128 v[148:151], v160 offset:256
  ds_read_b128 v[152:155], v160 offset:8448
  v_mfma_f32_16x16x32_bf16 a[252:255], a[160:163], v[224:227], a[252:255]
  ds_read_b64_tr_b16 v[40:41], v3 offset:18432
  ds_read_b64_tr_b16 v[42:43], v3 offset:19456
  ds_read_b64_tr_b16 v[44:45], v3 offset:20480
  s_waitcnt lgkmcnt(10)
  v_mfma_f32_16x16x32_f16 v[172:175], v[136:139], v[132:135], v[172:175]
  v_mfma_f32_16x16x32_bf16 a[248:251], a[36:39], v[224:227], a[248:251]
  s_waitcnt lgkmcnt(9)
  v_mfma_f32_16x16x32_f16 v[176:179], v[140:143], v[132:135], v[176:179]
  v_mfma_f32_16x16x32_bf16 a[252:255], a[164:167], v[224:227], a[252:255]
  ds_read_b64_tr_b16 v[46:47], v3 offset:21504
  ds_read_b64_tr_b16 v[48:49], v3 offset:22528
  ds_read_b64_tr_b16 v[50:51], v3 offset:23552
  s_waitcnt lgkmcnt(7)
  v_mfma_f32_16x16x32_f16 v[172:175], v[148:151], v[144:147], v[172:175]
  s_waitcnt lgkmcnt(6)
  v_mfma_f32_16x16x32_f16 v[176:179], v[152:155], v[144:147], v[176:179]
  ds_read_b64_tr_b16 v[52:53], v3 offset:24576
  ds_read_b64_tr_b16 v[54:55], v3 offset:25600
  ds_read_b64_tr_b16 v[56:57], v3 offset:26624
  v_min_u32 v247, 7, v255
  v_and_b32 v246, 1, v247
  v_lshlrev_b32 v247, 6, v247
  v_and_b32 v247, 384, v247
  v_lshl_or_b32 v247, v246, 3, v247
  v_lshlrev_b32 v246, 3, v229
  v_mov_b32 v132, 0
  v_mov_b32 v133, 0
  v_mov_b32 v134, 0
  v_mov_b32 v135, 0
  v_mov_b32 v136, 152064
  buffer_load_dwordx2 v[240:241], v247, s[60:63], s27 offen sc1
  s_mov_b64 exec, 1
  ds_write_b128 v136, v[132:135]
  ds_write_b128 v136, v[132:135] offset:3088
  s_mov_b64 exec, -1
  v_mul_f32 v172, s68, v172
  v_mul_f32 v173, s68, v173
  v_mul_f32 v174, s68, v174
  v_mul_f32 v175, s68, v175
  v_mul_f32 v176, s68, v176
  v_mul_f32 v177, s68, v177
  v_mul_f32 v178, s68, v178
  v_mul_f32 v179, s68, v179
  ds_write_b64 v184, v[172:173]
  ds_write_b64 v185, v[174:175]
  s_mov_b32 exec_hi, 0
  ds_write_b32 v186, v176 offset:2048
  ds_write_b32 v186, v177 offset:2176
  ds_write_b32 v186, v178 offset:2304
  ds_write_b32 v186, v179 offset:2432
  s_mov_b32 exec_hi, -1
  s_lshl_b32 s35, s43, 15
  s_lshl_b32 s36, s42, 12
  s_add_u32 s35, s35, s36
  s_lshl_b32 s36, s3, 16
  s_lshl_b32 s37, s43, 15
  s_add_u32 s36, s36, s37
  s_and_b32 s39, s40, 0
  s_add_u32 s39, s39, s42
  s_lshl_b32 s39, s39, 12
  v_add_u32 v181, s37, v222
  v_lshrrev_b32 v182, 1, v255
  ds_read_b64_tr_b16 v[58:59], v3 offset:27648
  v_mul_u32_u24 v182, 4160, v182
  ds_read_b64_tr_b16 v[60:61], v3 offset:28672
  v_and_b32 v183, 1, v255
  ds_read_b64_tr_b16 v[62:63], v3 offset:29696
  v_lshl_add_u32 v182, v183, 4, v182
  ds_read_b64_tr_b16 v[64:65], v3 offset:30720
  v_add_u32 v151, 73728, v182
  ds_read_b64_tr_b16 v[66:67], v3 offset:31744
  v_lshlrev_b32 v180, 4, v0
  ds_read_b64_tr_b16 v[68:69], v3 offset:32768
  v_add_u32 v150, 69632, v180
  ds_read_b64_tr_b16 v[70:71], v3 offset:33792
  v_mov_b32 v184, 0
  ds_read_b64_tr_b16 v[72:73], v3 offset:34816
  v_mov_b32 v185, 0
  ds_read_b64_tr_b16 v[74:75], v3 offset:35840
  v_mov_b32 v186, 0
  ds_read_b64_tr_b16 v[76:77], v3 offset:36864
  v_mov_b32 v187, 0
  ds_read_b64_tr_b16 v[78:79], v3 offset:37888
  v_and_b32 v180, 1, v255
  ds_read_b64_tr_b16 v[80:81], v3 offset:38912
  v_mul_u32_u24 v180, 4160, v180
  ds_read_b64_tr_b16 v[82:83], v3 offset:39936
  v_bfe_u32 v183, v255, 1, 3
  ds_read_b64_tr_b16 v[84:85], v3 offset:40960
  v_lshlrev_b32 v183, 2, v183
  ds_read_b64_tr_b16 v[86:87], v3 offset:41984
  v_sub_u32 v180, v180, v183
  ds_read_b64_tr_b16 v[88:89], v3 offset:43008
  v_lshrrev_b32 v182, 4, v255
  ds_read_b64_tr_b16 v[90:91], v3 offset:44032
  v_lshl_add_u32 v180, v182, 4, v180
  ds_read_b64_tr_b16 v[92:93], v3 offset:45056
  s_mul_i32 s34, s43, 8320
  ds_read_b64_tr_b16 v[94:95], v3 offset:46080
  s_lshl_b32 s38, s42, 8
  ds_read_b64_tr_b16 v[96:97], v3 offset:47104
  s_sub_u32 s34, s34, s38
  ds_read_b64_tr_b16 v[98:99], v3 offset:48128
  s_add_u32 s34, s34, 69660
  ds_read_b64_tr_b16 v[100:101], v3 offset:49152
  v_add_u32 v242, s34, v180
  ds_read_b64_tr_b16 v[102:103], v3 offset:50176
  v_and_b32 v183, 15, v255
  ds_read_b64_tr_b16 v[104:105], v3 offset:51200
  v_lshlrev_b32 v183, 5, v183
  ds_read_b64_tr_b16 v[106:107], v3 offset:52224
  v_lshl_add_u32 v180, v182, 4, v183
  ds_read_b64_tr_b16 v[108:109], v3 offset:53248
  s_mul_i32 s65, s43, 5088
  ds_read_b64_tr_b16 v[110:111], v3 offset:54272
  s_sub_u32 s34, s65, s38
  ds_read_b64_tr_b16 v[112:113], v3 offset:55296
  s_add_u32 s34, s34, 152576
  ds_read_b64_tr_b16 v[114:115], v3 offset:56320
  v_add_u32 v212, s34, v180
  ds_read_b64_tr_b16 v[116:117], v3 offset:57344
  v_lshl_add_u32 v179, v182, 3, v183
  ds_read_b64_tr_b16 v[118:119], v3 offset:58368
  v_lshlrev_b32 v1, 2, v255
  ds_read_b64_tr_b16 v[120:121], v3 offset:59392
  s_lshl_b32 s26, s3, 13
  ds_read_b64_tr_b16 v[122:123], v3 offset:60416
  s_lshl_b32 s34, s40, 10
  ds_read_b64_tr_b16 v[124:125], v3 offset:61440
  s_add_u32 s26, s26, s34
  ds_read_b64_tr_b16 v[126:127], v3 offset:62464
  s_lshl_b32 s34, s42, 9
  ds_read_b64_tr_b16 v[128:129], v3 offset:63488
  s_add_u32 s26, s26, s34
  ds_read_b64_tr_b16 v[130:131], v3 offset:64512
  s_lshl_b32 s34, s43, 8
  s_add_u32 s26, s26, s34
  s_add_u32 s26, s26, 18874368
  s_mul_i32 s64, s40, 270336
  s_and_b32 s34, s50, 63
  s_lshl_b32 s34, s34, 7
  s_add_u32 s64, s64, s34
  s_add_u32 s64, s64, 12582912
  v_lshrrev_b32 v180, 3, v255
  v_mul_u32_u24 v180, 8448, v180
  v_and_b32 v183, 7, v255
  v_lshl_add_u32 v183, v183, 4, v180
  v_add_u32 v182, 152064, v222
  s_add_u32 s37, s23, 2097152
  s_add_u32 s38, s24, 32768
  s_waitcnt vmcnt(1)
  ds_read_b64_tr_b16 a[40:41], v248 offset:0
  ds_read_b64_tr_b16 a[42:43], v248 offset:1024
  ds_read_b64_tr_b16 a[168:169], v249 offset:0
  ds_read_b64_tr_b16 a[170:171], v249 offset:1024
  ds_read_b64_tr_b16 a[44:45], v248 offset:2048
  ds_read_b64_tr_b16 a[46:47], v248 offset:3072
  ds_read_b64_tr_b16 a[172:173], v249 offset:2048
  ds_read_b64_tr_b16 a[174:175], v249 offset:3072
  s_waitcnt lgkmcnt(0)
  s_add_u32 m0, s75, 0
  s_add_u32 s70, s70, 114688
  s_cmp_eq_u32 s70, s72
  s_cselect_b32 s70, s71, s70
  buffer_load_dwordx4 v232, s[8:11], s70 offen offset:0 lds
  buffer_load_dwordx4 v233, s[8:11], s70 offen offset:1024 lds
  buffer_load_dwordx4 v234, s[8:11], s70 offen offset:2048 lds
  buffer_load_dwordx4 v235, s[8:11], s70 offen offset:3072 lds
  s_barrier
  ds_read_b32 v132, v213 offset:0
  ds_read_b32 v133, v214 offset:0
  ds_read_b32 v134, v215 offset:0
  ds_read_b32 v135, v216 offset:0
  ds_read_b32 v136, v217 offset:0
  ds_read_b32 v137, v218 offset:0
  ds_read_b32 v138, v219 offset:0
  ds_read_b32 v139, v220 offset:0
  ds_read_b32 v140, v221 offset:0
  ds_read_b32 v141, v213 offset:3088
  ds_read_b32 v142, v214 offset:3088
  ds_read_b32 v143, v215 offset:3088
  ds_read_b32 v144, v216 offset:3088
  ds_read_b32 v145, v217 offset:3088
  ds_read_b32 v146, v218 offset:3088
  ds_read_b32 v147, v219 offset:3088
  ds_read_b32 v148, v220 offset:3088
  ds_read_b32 v149, v221 offset:3088
  s_waitcnt vmcnt(4)
  v_cmp_ne_u64 vcc, s[20:21], v[240:241]
  s_nop 4
  s_cbranch_vccz PK_4
  s_mov_b32 s25, 0
PL_5:
  buffer_load_dwordx2 v[240:241], v247, s[60:63], s27 offen sc1
  s_add_u32 s25, s25, 1
  s_waitcnt vmcnt(0)
  v_cmp_ne_u64 vcc, s[20:21], v[240:241]
  s_cmp_gt_u32 s25, 0x40000
  s_cbranch_scc1 PK_4
  s_nop 2
  s_cbranch_vccnz PL_5
PK_4:
  buffer_load_dwordx2 v[2:3], v246, s[60:63], s32 offen sc1
  s_waitcnt lgkmcnt(15)
  v_cvt_pk_bf16_f32 v152, v133, v134
  s_add_u32 m0, s35, 0
  s_add_u32 s66, s39, 0
  s_and_b32 s66, s66, 0x7fff
  s_add_u32 s66, s66, s36
  s_waitcnt lgkmcnt(13)
  v_cvt_pk_bf16_f32 v153, v135, v136
  buffer_load_dwordx4 v222, s[60:63], s66 offen offset:0 lds
  s_waitcnt lgkmcnt(11)
  v_cvt_pk_bf16_f32 v154, v137, v138
  buffer_load_dwordx4 v222, s[60:63], s66 offen offset:1024 lds
  s_waitcnt lgkmcnt(9)
  v_cvt_pk_bf16_f32 v155, v139, v140
  buffer_load_dwordx4 v222, s[60:63], s66 offen offset:2048 lds
  ds_write_b128 v150, v[152:155] offset:0
  buffer_load_dwordx4 v222, s[60:63], s66 offen offset:3072 lds
  v_cvt_pk_bf16_f32 v156, v132, v133
  s_add_u32 m0, s35, 8192
  s_add_u32 s66, s39, 8192
  s_and_b32 s66, s66, 0x7fff
  s_add_u32 s66, s66, s36
  v_cvt_pk_bf16_f32 v157, v134, v135
  buffer_load_dwordx4 v222, s[60:63], s66 offen offset:0 lds
  v_cvt_pk_bf16_f32 v158, v136, v137
  buffer_load_dwordx4 v222, s[60:63], s66 offen offset:1024 lds
  v_cvt_pk_bf16_f32 v159, v138, v139
  buffer_load_dwordx4 v222, s[60:63], s66 offen offset:2048 lds
  ds_write_b128 v150, v[156:159] offset:4160
  buffer_load_dwordx4 v222, s[60:63], s66 offen offset:3072 lds
  s_add_u32 m0, s35, 16384
  s_add_u32 s66, s39, 16384
  s_and_b32 s66, s66, 0x7fff
  s_add_u32 s66, s66, s36
  buffer_load_dwordx4 v222, s[60:63], s66 offen offset:0 lds
  buffer_load_dwordx4 v222, s[60:63], s66 offen offset:1024 lds
  buffer_load_dwordx4 v222, s[60:63], s66 offen offset:2048 lds
  buffer_load_dwordx4 v222, s[60:63], s66 offen offset:3072 lds
  s_add_u32 m0, s35, 24576
  s_add_u32 s66, s39, 24576
  s_and_b32 s66, s66, 0x7fff
  s_add_u32 s66, s66, s36
  buffer_load_dwordx4 v222, s[60:63], s66 offen offset:0 lds
  buffer_load_dwordx4 v222, s[60:63], s66 offen offset:1024 lds
  buffer_load_dwordx4 v222, s[60:63], s66 offen offset:2048 lds
  buffer_load_dwordx4 v222, s[60:63], s66 offen offset:3072 lds
  s_waitcnt vmcnt(12)
  s_waitcnt lgkmcnt(0)
  s_barrier
  ds_read_b128 v[160:163], v181 offset:0
  ds_read_b128 v[164:167], v181 offset:1024
  ds_read_b128 v[168:171], v181 offset:2048
  ds_read_b128 v[172:175], v181 offset:3072
  s_waitcnt lgkmcnt(2)
  v_mfma_f32_32x32x16_bf16 v[188:203], v[4:7], v[160:163], v[188:203]
  ds_read_b128 v[216:219], v181 offset:4096
  s_add_u32 m0, s69, 0
  s_add_u32 s70, s70, 114688
  s_cmp_eq_u32 s70, s72
  s_cselect_b32 s70, s71, s70
  v_cvt_pk_bf16_f32 v152, v142, v143
  v_cvt_pk_bf16_f32 v153, v144, v145
  v_cvt_pk_bf16_f32 v154, v146, v147
  v_mfma_f32_32x32x16_bf16 v[188:203], v[8:11], v[164:167], v[188:203]
  ds_read_b128 v[160:163], v181 offset:5120
  v_cmp_ne_u64 vcc, s[20:21], v[2:3]
  s_nop 4
  s_cbranch_vccz PK_6
  s_mov_b32 s25, 0
PL_7:
  buffer_load_dwordx2 v[2:3], v246, s[60:63], s32 offen sc1
  s_add_u32 s25, s25, 1
  s_waitcnt vmcnt(0)
  v_cmp_ne_u64 vcc, s[20:21], v[2:3]
  s_cmp_gt_u32 s25, 0x40000
  s_cbranch_scc1 PK_6
  s_nop 2
  s_cbranch_vccnz PL_7
PK_6:
  buffer_load_dwordx4 v232, s[8:11], s70 offen offset:0 lds
  v_cvt_pk_bf16_f32 v155, v148, v149
  ds_write_b128 v150, v[152:155] offset:8320
  v_cvt_pk_bf16_f32 v156, v141, v142
  s_waitcnt lgkmcnt(3)
  v_mfma_f32_32x32x16_bf16 v[188:203], v[12:15], v[168:171], v[188:203]
  ds_read_b128 v[164:167], v181 offset:6144
  buffer_load_dwordx4 v233, s[8:11], s70 offen offset:1024 lds
  v_cvt_pk_bf16_f32 v157, v143, v144
  v_cvt_pk_bf16_f32 v158, v145, v146
  v_cvt_pk_bf16_f32 v159, v147, v148
  v_mfma_f32_32x32x16_bf16 v[188:203], v[16:19], v[172:175], v[188:203]
  ds_read_b128 v[168:171], v181 offset:7168
  buffer_load_dwordx4 v234, s[8:11], s70 offen offset:2048 lds
  ds_write_b128 v150, v[156:159] offset:12480
  s_waitcnt vmcnt(11)
  s_barrier
  s_waitcnt lgkmcnt(4)
  v_mfma_f32_32x32x16_bf16 v[188:203], v[20:23], v[216:219], v[188:203]
  ds_read_b128 v[172:175], v181 offset:8192
  buffer_load_dwordx4 v235, s[8:11], s70 offen offset:3072 lds
  s_mov_b64 exec, 0xff
  ds_write_b128 v151, v[184:187]
  s_mov_b64 exec, -1
  v_mfma_f32_32x32x16_bf16 v[188:203], v[24:27], v[160:163], v[188:203]
  ds_read_b128 v[216:219], v181 offset:9216
  s_add_u32 m0, s69, 4096
  s_add_u32 s70, s70, 114688
  s_cmp_eq_u32 s70, s72
  s_cselect_b32 s70, s71, s70
  s_mov_b32 exec_hi, 0x3fffffff
  ds_write_b128 v182, v[184:187]
  ds_write_b128 v182, v[184:187] offset:5088
  s_mov_b32 exec_hi, -1
  s_waitcnt lgkmcnt(6)
  v_mfma_f32_32x32x16_bf16 v[188:203], v[28:31], v[164:167], v[188:203]
  ds_read_b128 v[160:163], v181 offset:10240
  buffer_load_dwordx4 v232, s[8:11], s70 offen offset:0 lds
  v_mfma_f32_32x32x16_bf16 v[188:203], v[32:35], v[168:171], v[188:203]
  ds_read_b128 v[164:167], v181 offset:11264
  buffer_load_dwordx4 v233, s[8:11], s70 offen offset:1024 lds
  s_waitcnt lgkmcnt(4)
  v_mfma_f32_32x32x16_bf16 v[188:203], v[36:39], v[172:175], v[188:203]
  ds_read_b128 v[168:171], v181 offset:12288
  buffer_load_dwordx4 v234, s[8:11], s70 offen offset:2048 lds
  v_mfma_f32_32x32x16_bf16 v[188:203], v[40:43], v[216:219], v[188:203]
  ds_read_b128 v[172:175], v181 offset:13312
  buffer_load_dwordx4 v235, s[8:11], s70 offen offset:3072 lds
  s_waitcnt lgkmcnt(2)
  v_mfma_f32_32x32x16_bf16 v[188:203], v[44:47], v[160:163], v[188:203]
  ds_read_b128 v[216:219], v181 offset:14336
  s_add_u32 m0, s65, 153056
  s_nop 0
  buffer_load_dwordx4 v183, s[60:63], s64 offen offset:0 lds
  s_add_u32 s64, s64, 66560
  v_mfma_f32_32x32x16_bf16 v[188:203], v[48:51], v[164:167], v[188:203]
  ds_read_b128 v[160:163], v181 offset:15360
  buffer_load_dwordx4 v183, s[60:63], s64 offen offset:1024 lds
  s_add_u32 s64, s64, 66560
  s_waitcnt vmcnt(14)
  s_barrier
  s_waitcnt lgkmcnt(2)
  v_mfma_f32_32x32x16_bf16 v[188:203], v[52:55], v[168:171], v[188:203]
  ds_read_b128 v[164:167], v181 offset:16384
  buffer_load_dwordx4 v183, s[60:63], s64 offen offset:2048 lds
  s_add_u32 s64, s64, 66560
  v_mfma_f32_32x32x16_bf16 v[188:203], v[56:59], v[172:175], v[188:203]
  ds_read_b128 v[168:171], v181 offset:17408
  buffer_load_dwordx4 v183, s[60:63], s64 offen offset:3072 lds
  s_waitcnt lgkmcnt(2)
  v_mfma_f32_32x32x16_bf16 v[188:203], v[60:63], v[216:219], v[188:203]
  ds_read_b128 v[172:175], v181 offset:18432
  ds_read_b64_tr_b16 a[48:49], v248 offset:0
  ds_read_b64_tr_b16 a[50:51], v248 offset:1024
  v_mfma_f32_32x32x16_bf16 v[188:203], v[64:67], v[160:163], v[188:203]
  ds_read_b128 v[216:219], v181 offset:19456
  ds_read_b64_tr_b16 a[176:177], v249 offset:0
  ds_read_b64_tr_b16 a[178:179], v249 offset:1024
  s_waitcnt lgkmcnt(6)
  v_mfma_f32_32x32x16_bf16 v[188:203], v[68:71], v[164:167], v[188:203]
  ds_read_b128 v[160:163], v181 offset:20480
  ds_read_b64_tr_b16 a[52:53], v248 offset:2048
  ds_read_b64_tr_b16 a[54:55], v248 offset:3072
  v_mfma_f32_32x32x16_bf16 v[188:203], v[72:75], v[168:171], v[188:203]
  ds_read_b128 v[164:167], v181 offset:21504
  ds_read_b64_tr_b16 a[180:181], v249 offset:2048
  ds_read_b64_tr_b16 a[182:183], v249 offset:3072
  s_waitcnt lgkmcnt(8)
  v_mfma_f32_32x32x16_bf16 v[188:203], v[76:79], v[172:175], v[188:203]
  ds_read_b128 v[168:171], v181 offset:22528
  s_waitcnt lgkmcnt(1)
  s_add_u32 m0, s75, 0
  s_add_u32 s70, s70, 114688
  s_cmp_eq_u32 s70, s72
  s_cselect_b32 s70, s71, s70
  v_mfma_f32_32x32x16_bf16 v[188:203], v[80:83], v[216:219], v[188:203]
  ds_read_b128 v[172:175], v181 offset:23552
  buffer_load_dwordx4 v232, s[8:11], s70 offen offset:0 lds
  s_waitcnt vmcnt(13)
  s_barrier
  v_mfma_f32_32x32x16_bf16 v[188:203], v[84:87], v[160:163], v[188:203]
  ds_read_b128 v[216:219], v181 offset:24576
  buffer_load_dwordx4 v233, s[8:11], s70 offen offset:1024 lds
  v_mfma_f32_32x32x16_bf16 v[188:203], v[88:91], v[164:167], v[188:203]
  ds_read_b128 v[160:163], v181 offset:25600
  buffer_load_dwordx4 v234, s[8:11], s70 offen offset:2048 lds
  s_waitcnt lgkmcnt(2)
  v_mfma_f32_32x32x16_bf16 v[188:203], v[92:95], v[168:171], v[188:203]
  ds_read_b128 v[164:167], v181 offset:26624
  buffer_load_dwordx4 v235, s[8:11], s70 offen offset:3072 lds
  v_mfma_f32_32x32x16_bf16 v[188:203], v[96:99], v[172:175], v[188:203]
  ds_read_b128 v[168:171], v181 offset:27648
  s_waitcnt vmcnt(12)
  ds_read_b64_tr_b16 a[56:57], v252 offset:0
  ds_read_b64_tr_b16 a[58:59], v252 offset:1024
  s_waitcnt lgkmcnt(4)
  v_mfma_f32_32x32x16_bf16 v[188:203], v[100:103], v[216:219], v[188:203]
  ds_read_b128 v[172:175], v181 offset:28672
  ds_read_b64_tr_b16 a[184:185], v253 offset:0
  ds_read_b64_tr_b16 a[186:187], v253 offset:1024
  v_mfma_f32_32x32x16_bf16 v[188:203], v[104:107], v[160:163], v[188:203]
  ds_read_b128 v[216:219], v181 offset:29696
  ds_read_b64_tr_b16 a[60:61], v252 offset:2048
  ds_read_b64_tr_b16 a[62:63], v252 offset:3072
  s_waitcnt lgkmcnt(8)
  v_mfma_f32_32x32x16_bf16 v[188:203], v[108:111], v[164:167], v[188:203]
  ds_read_b128 v[160:163], v181 offset:30720
  ds_read_b64_tr_b16 a[188:189], v253 offset:2048
  ds_read_b64_tr_b16 a[190:191], v253 offset:3072
  v_mfma_f32_32x32x16_bf16 v[188:203], v[112:115], v[168:171], v[188:203]
  ds_read_b128 v[164:167], v181 offset:31744
  s_waitcnt lgkmcnt(1)
  s_add_u32 m0, s69, 0
  s_add_u32 s70, s70, 114688
  s_cmp_eq_u32 s70, s72
  s_cselect_b32 s70, s71, s70
  v_mfma_f32_32x32x16_bf16 v[188:203], v[116:119], v[172:175], v[188:203]
  buffer_load_dwordx4 v232, s[8:11], s70 offen offset:0 lds
  v_mfma_f32_32x32x16_bf16 v[188:203], v[120:123], v[216:219], v[188:203]
  buffer_load_dwordx4 v233, s[8:11], s70 offen offset:1024 lds
  s_waitcnt lgkmcnt(0)
  v_mfma_f32_32x32x16_bf16 v[188:203], v[124:127], v[160:163], v[188:203]
  buffer_load_dwordx4 v234, s[8:11], s70 offen offset:2048 lds
  v_mfma_f32_32x32x16_bf16 v[188:203], v[128:131], v[164:167], v[188:203]
  buffer_load_dwordx4 v235, s[8:11], s70 offen offset:3072 lds
  v_accvgpr_read_b32 v168, a248
  v_accvgpr_read_b32 v169, a249
  v_accvgpr_read_b32 v170, a250
  v_accvgpr_read_b32 v171, a251
  v_accvgpr_read_b32 v172, a252
  v_accvgpr_read_b32 v173, a253
  v_accvgpr_read_b32 v174, a254
  v_accvgpr_read_b32 v175, a255
  v_mov_b32 v2, 0
  v_mov_b32 v3, 0
  s_nop 0
  v_cvt_pk_bf16_f32 v4, v188, v189
  v_cvt_pk_bf16_f32 v5, v190, v191
  v_cvt_pk_bf16_f32 v6, v192, v193
  v_cvt_pk_bf16_f32 v7, v194, v195
  buffer_store_dwordx4 v[4:7], v222, s[60:63], s37 offen sc1
  v_cvt_pk_bf16_f32 v8, v196, v197
  v_cvt_pk_bf16_f32 v9, v198, v199
  v_cvt_pk_bf16_f32 v10, v200, v201
  v_cvt_pk_bf16_f32 v11, v202, v203
  buffer_store_dwordx4 v[8:11], v222, s[60:63], s37 offen offset:1024 sc1
  v_dot2c_f32_bf16 v2, s33, v4
  v_dot2c_f32_bf16 v3, v4, v4
  v_dot2c_f32_bf16 v2, s33, v5
  v_dot2c_f32_bf16 v3, v5, v5
  v_dot2c_f32_bf16 v2, s33, v6
  v_dot2c_f32_bf16 v3, v6, v6
  v_dot2c_f32_bf16 v2, s33, v7
  v_dot2c_f32_bf16 v3, v7, v7
  v_dot2c_f32_bf16 v2, s33, v8
  v_dot2c_f32_bf16 v3, v8, v8
  v_dot2c_f32_bf16 v2, s33, v9
  v_dot2c_f32_bf16 v3, v9, v9
  v_dot2c_f32_bf16 v2, s33, v10
  v_dot2c_f32_bf16 v3, v10, v10
  v_dot2c_f32_bf16 v2, s33, v11
  v_dot2c_f32_bf16 v3, v11, v11
  s_nop 2
  v_permlane32_swap_b32 v2, v3
  v_add_f32 v2, v2, v3
  buffer_store_dword v2, v1, s[60:63], s26 offen sc1
  v_add_u32 v1, 1024, v242
  v_add_u32 v2, 2048, v242
  v_add_u32 v3, 3072, v242
  s_waitcnt vmcnt(11)
  ds_read_b128 v[100:103], v212 offset:448
  ds_read2_b32 v[36:37], v3 offset0:240 offset1:241
  ds_read2_b32 v[38:39], v3 offset0:242 offset1:243
  ds_read_b128 v[104:107], v212 offset:960
  ds_read2_b32 v[40:41], v3 offset0:112 offset1:113
  ds_read2_b32 v[42:43], v3 offset0:114 offset1:115
  ds_read_b128 v[108:111], v212 offset:1472
  ds_read2_b32 v[44:45], v2 offset0:240 offset1:241
  ds_read2_b32 v[46:47], v2 offset0:242 offset1:243
  ds_read_b128 v[112:115], v212 offset:1984
  ds_read2_b32 v[48:49], v2 offset0:112 offset1:113
  ds_read2_b32 v[50:51], v2 offset0:114 offset1:115
  ds_read_b128 v[116:119], v212 offset:2496
  ds_read2_b32 v[52:53], v1 offset0:240 offset1:241
  ds_read2_b32 v[54:55], v1 offset0:242 offset1:243
  ds_read_b128 v[120:123], v212 offset:3008
  ds_read2_b32 v[56:57], v1 offset0:112 offset1:113
  ds_read2_b32 v[58:59], v1 offset0:114 offset1:115
  ds_read_b128 v[124:127], v212 offset:3520
  ds_read2_b32 v[60:61], v242 offset0:240 offset1:241
  ds_read2_b32 v[62:63], v242 offset0:242 offset1:243
  ds_read_b128 v[128:131], v212 offset:4032
  ds_read2_b32 v[64:65], v242 offset0:112 offset1:113
  ds_read2_b32 v[66:67], v242 offset0:114 offset1:115
  s_waitcnt lgkmcnt(15)
  v_mfma_f32_16x16x32_bf16 v[4:7], v[36:39], v[100:103], 0
  ds_read_b128 v[132:135], v212 offset:384
  v_mfma_f32_16x16x32_bf16 v[168:171], a[40:43], v[224:227], v[168:171]
  v_mfma_f32_16x16x32_bf16 v[8:11], v[36:39], v[104:107], 0
  ds_read2_b32 v[68:69], v3 offset0:224 offset1:225
  v_mfma_f32_16x16x32_bf16 v[172:175], a[168:171], v[224:227], v[172:175]
  v_mfma_f32_16x16x32_bf16 v[8:11], v[40:43], v[100:103], v[8:11]
  ds_read2_b32 v[70:71], v3 offset0:226 offset1:227
  v_mfma_f32_16x16x32_bf16 v[168:171], a[44:47], v[224:227], v[168:171]
  v_mfma_f32_16x16x32_bf16 v[12:15], v[40:43], v[104:107], 0
  ds_read_b128 v[136:139], v212 offset:896
  v_mfma_f32_16x16x32_bf16 v[172:175], a[172:175], v[224:227], v[172:175]
  v_mfma_f32_16x16x32_bf16 v[12:15], v[36:39], v[108:111], v[12:15]
  ds_read2_b32 v[72:73], v3 offset0:96 offset1:97
  v_mfma_f32_16x16x32_bf16 v[168:171], a[48:51], v[224:227], v[168:171]
  v_mfma_f32_16x16x32_bf16 v[12:15], v[44:47], v[100:103], v[12:15]
  ds_read2_b32 v[74:75], v3 offset0:98 offset1:99
  v_mfma_f32_16x16x32_bf16 v[172:175], a[176:179], v[224:227], v[172:175]
  v_mfma_f32_16x16x32_bf16 v[16:19], v[40:43], v[108:111], 0
  ds_read_b128 v[140:143], v212 offset:1408
  v_mfma_f32_16x16x32_bf16 v[168:171], a[52:55], v[224:227], v[168:171]
  v_mfma_f32_16x16x32_bf16 v[16:19], v[44:47], v[104:107], v[16:19]
  ds_read2_b32 v[76:77], v2 offset0:224 offset1:225
  v_mfma_f32_16x16x32_bf16 v[172:175], a[180:183], v[224:227], v[172:175]
  v_mfma_f32_16x16x32_bf16 v[20:23], v[44:47], v[108:111], 0
  ds_read_b64_tr_b16 a[64:65], v252 offset:4096
  ds_read_b64_tr_b16 a[66:67], v252 offset:5120
  v_mfma_f32_16x16x32_bf16 v[168:171], a[56:59], v[224:227], v[168:171]
  s_waitcnt lgkmcnt(15)
  v_mfma_f32_16x16x32_bf16 v[16:19], v[36:39], v[112:115], v[16:19]
  ds_read2_b32 v[78:79], v2 offset0:226 offset1:227
  v_mfma_f32_16x16x32_bf16 v[172:175], a[184:187], v[224:227], v[172:175]
  v_mfma_f32_16x16x32_bf16 v[16:19], v[48:51], v[100:103], v[16:19]
  ds_read_b128 v[144:147], v212 offset:1920
  v_mfma_f32_16x16x32_bf16 v[168:171], a[60:63], v[224:227], v[168:171]
  v_mfma_f32_16x16x32_bf16 v[20:23], v[40:43], v[112:115], v[20:23]
  ds_read_b64_tr_b16 a[192:193], v253 offset:4096
  ds_read_b64_tr_b16 a[194:195], v253 offset:5120
  v_mfma_f32_16x16x32_bf16 v[172:175], a[188:191], v[224:227], v[172:175]
  v_mfma_f32_16x16x32_bf16 v[20:23], v[48:51], v[104:107], v[20:23]
  ds_read2_b32 v[80:81], v2 offset0:96 offset1:97
  v_mfma_f32_16x16x32_bf16 v[24:27], v[44:47], v[112:115], 0
  ds_read2_b32 v[82:83], v2 offset0:98 offset1:99
  v_mfma_f32_16x16x32_bf16 v[24:27], v[48:51], v[108:111], v[24:27]
  ds_read_b64_tr_b16 a[68:69], v252 offset:6144
  ds_read_b64_tr_b16 a[70:71], v252 offset:7168
  v_mfma_f32_16x16x32_bf16 v[28:31], v[48:51], v[112:115], 0
  ds_read_b128 v[148:151], v212 offset:2432
  v_mfma_f32_16x16x32_bf16 v[20:23], v[36:39], v[116:119], v[20:23]
  ds_read2_b32 v[84:85], v1 offset0:224 offset1:225
  v_mfma_f32_16x16x32_bf16 v[20:23], v[52:55], v[100:103], v[20:23]
  ds_read_b64_tr_b16 a[196:197], v253 offset:6144
  ds_read_b64_tr_b16 a[198:199], v253 offset:7168
  v_mfma_f32_16x16x32_bf16 v[24:27], v[40:43], v[116:119], v[24:27]
  ds_read2_b32 v[86:87], v1 offset0:226 offset1:227
  v_mfma_f32_16x16x32_bf16 v[24:27], v[52:55], v[104:107], v[24:27]
  ds_read_b128 v[152:155], v212 offset:2944
  v_mfma_f32_16x16x32_bf16 v[28:31], v[44:47], v[116:119], v[28:31]
  s_waitcnt lgkmcnt(2)
  s_add_u32 m0, s69, 4096
  s_add_u32 s70, s70, 114688
  s_cmp_eq_u32 s70, s72
  s_cselect_b32 s70, s71, s70
  buffer_load_dwordx4 v232, s[8:11], s70 offen offset:0 lds
  v_mfma_f32_16x16x32_bf16 v[28:31], v[52:55], v[108:111], v[28:31]
  ds_read2_b32 v[88:89], v1 offset0:96 offset1:97
  v_mfma_f32_16x16x32_bf16 v[32:35], v[48:51], v[116:119], 0
  ds_read2_b32 v[90:91], v1 offset0:98 offset1:99
  v_mfma_f32_16x16x32_bf16 v[32:35], v[52:55], v[112:115], v[32:35]
  buffer_load_dwordx4 v233, s[8:11], s70 offen offset:1024 lds
  buffer_load_dwordx4 v234, s[8:11], s70 offen offset:2048 lds
  v_mfma_f32_16x16x32_bf16 v[24:27], v[36:39], v[120:123], v[24:27]
  ds_read_b128 v[156:159], v212 offset:3456
  v_mfma_f32_16x16x32_bf16 v[24:27], v[56:59], v[100:103], v[24:27]
  ds_read2_b32 v[92:93], v242 offset0:224 offset1:225
  v_mfma_f32_16x16x32_bf16 v[28:31], v[40:43], v[120:123], v[28:31]
  buffer_load_dwordx4 v235, s[8:11], s70 offen offset:3072 lds
  s_waitcnt vmcnt(11)
  ds_read_b64_tr_b16 a[72:73], v248 offset:0
  v_mfma_f32_16x16x32_bf16 v[28:31], v[56:59], v[104:107], v[28:31]
  ds_read2_b32 v[94:95], v242 offset0:226 offset1:227
  v_mfma_f32_16x16x32_bf16 v[32:35], v[44:47], v[120:123], v[32:35]
  ds_read_b128 v[160:163], v212 offset:3968
  v_mfma_f32_16x16x32_bf16 v[32:35], v[56:59], v[108:111], v[32:35]
  ds_read_b64_tr_b16 a[74:75], v248 offset:1024
  ds_read_b64_tr_b16 a[200:201], v249 offset:0
  v_mfma_f32_16x16x32_bf16 v[28:31], v[36:39], v[124:127], v[28:31]
  ds_read2_b32 v[96:97], v242 offset0:96 offset1:97
  v_mfma_f32_16x16x32_bf16 v[28:31], v[60:63], v[100:103], v[28:31]
  ds_read2_b32 v[98:99], v242 offset0:98 offset1:99
  s_waitcnt vmcnt(4)
  s_barrier
  buffer_store_dwordx2 v[244:245], v243, s[60:63], s38 offen sc1
  v_mfma_f32_16x16x32_bf16 v[32:35], v[40:43], v[124:127], v[32:35]
  ds_read_b64_tr_b16 a[202:203], v249 offset:1024
  ds_read_b64_tr_b16 a[76:77], v248 offset:2048
  v_mfma_f32_16x16x32_bf16 v[32:35], v[60:63], v[104:107], v[32:35]
  ds_read_b64_tr_b16 a[78:79], v248 offset:3072
  ds_read_b64_tr_b16 a[204:205], v249 offset:2048
  v_mfma_f32_16x16x32_bf16 v[32:35], v[36:39], v[128:131], v[32:35]
  ds_read_b64_tr_b16 a[206:207], v249 offset:3072
  s_waitcnt lgkmcnt(0)
  s_add_u32 m0, s75, 0
  s_add_u32 s70, s70, 114688
  s_cmp_eq_u32 s70, s72
  s_cselect_b32 s70, s71, s70
  v_mfma_f32_16x16x32_bf16 v[32:35], v[64:67], v[100:103], v[32:35]
  buffer_load_dwordx4 v232, s[8:11], s70 offen offset:0 lds
  buffer_load_dwordx4 v233, s[8:11], s70 offen offset:1024 lds
  v_mfma_f32_16x16x32_bf16 v[4:7], v[68:71], v[132:135], v[4:7]
  ds_read_b128 v[100:103], v212 offset:320
  v_mfma_f32_16x16x32_bf16 v[8:11], v[68:71], v[136:139], v[8:11]
  ds_read2_b32 v[36:37], v3 offset0:208 offset1:209
  v_mfma_f32_16x16x32_bf16 v[8:11], v[72:75], v[132:135], v[8:11]
  buffer_load_dwordx4 v234, s[8:11], s70 offen offset:2048 lds
  buffer_load_dwordx4 v235, s[8:11], s70 offen offset:3072 lds
  v_mfma_f32_16x16x32_bf16 v[12:15], v[72:75], v[136:139], v[12:15]
  ds_read2_b32 v[38:39], v3 offset0:210 offset1:211
  v_mfma_f32_16x16x32_bf16 v[12:15], v[68:71], v[140:143], v[12:15]
  ds_read_b128 v[104:107], v212 offset:832
  v_mfma_f32_16x16x32_bf16 v[12:15], v[76:79], v[132:135], v[12:15]
  v_mfma_f32_16x16x32_bf16 v[168:171], a[64:67], v[224:227], v[168:171]
  v_mfma_f32_16x16x32_bf16 v[172:175], a[192:195], v[224:227], v[172:175]
  v_mfma_f32_16x16x32_bf16 v[16:19], v[72:75], v[140:143], v[16:19]
  ds_read2_b32 v[40:41], v3 offset0:80 offset1:81
  v_mfma_f32_16x16x32_bf16 v[16:19], v[76:79], v[136:139], v[16:19]
  ds_read2_b32 v[42:43], v3 offset0:82 offset1:83
  v_mfma_f32_16x16x32_bf16 v[20:23], v[76:79], v[140:143], v[20:23]
  v_mfma_f32_16x16x32_bf16 v[168:171], a[68:71], v[224:227], v[168:171]
  v_mfma_f32_16x16x32_bf16 v[172:175], a[196:199], v[224:227], v[172:175]
  v_mfma_f32_16x16x32_bf16 v[16:19], v[68:71], v[144:147], v[16:19]
  ds_read_b128 v[108:111], v212 offset:1344
  v_mfma_f32_16x16x32_bf16 v[16:19], v[80:83], v[132:135], v[16:19]
  ds_read2_b32 v[44:45], v2 offset0:208 offset1:209
  v_mfma_f32_16x16x32_bf16 v[20:23], v[72:75], v[144:147], v[20:23]
  ds_read_b64_tr_b16 a[80:81], v252 offset:0
  ds_read_b64_tr_b16 a[82:83], v252 offset:1024
  v_mfma_f32_16x16x32_bf16 v[20:23], v[80:83], v[136:139], v[20:23]
  ds_read2_b32 v[46:47], v2 offset0:210 offset1:211
  v_mfma_f32_16x16x32_bf16 v[24:27], v[76:79], v[144:147], v[24:27]
  ds_read_b128 v[112:115], v212 offset:1856
  v_mfma_f32_16x16x32_bf16 v[24:27], v[80:83], v[140:143], v[24:27]
  ds_read_b64_tr_b16 a[208:209], v253 offset:0
  ds_read_b64_tr_b16 a[210:211], v253 offset:1024
  v_mfma_f32_16x16x32_bf16 v[28:31], v[80:83], v[144:147], v[28:31]
  ds_read2_b32 v[48:49], v2 offset0:80 offset1:81
  v_mfma_f32_16x16x32_bf16 v[20:23], v[68:71], v[148:151], v[20:23]
  ds_read2_b32 v[50:51], v2 offset0:82 offset1:83
  v_mfma_f32_16x16x32_bf16 v[20:23], v[84:87], v[132:135], v[20:23]
  ds_read_b64_tr_b16 a[84:85], v252 offset:2048
  ds_read_b64_tr_b16 a[86:87], v252 offset:3072
  v_mfma_f32_16x16x32_bf16 v[24:27], v[72:75], v[148:151], v[24:27]
  ds_read_b128 v[116:119], v212 offset:2368
  v_mfma_f32_16x16x32_bf16 v[24:27], v[84:87], v[136:139], v[24:27]
  ds_read2_b32 v[52:53], v1 offset0:208 offset1:209
  v_mfma_f32_16x16x32_bf16 v[28:31], v[76:79], v[148:151], v[28:31]
  ds_read_b64_tr_b16 a[212:213], v253 offset:2048
  ds_read_b64_tr_b16 a[214:215], v253 offset:3072
  v_mfma_f32_16x16x32_bf16 v[28:31], v[84:87], v[140:143], v[28:31]
  ds_read2_b32 v[54:55], v1 offset0:210 offset1:211
  v_mfma_f32_16x16x32_bf16 v[32:35], v[80:83], v[148:151], v[32:35]
  ds_read_b128 v[120:123], v212 offset:2880
  v_mfma_f32_16x16x32_bf16 v[32:35], v[84:87], v[144:147], v[32:35]
  s_waitcnt lgkmcnt(2)
  s_add_u32 m0, s69, 0
  s_add_u32 s70, s70, 114688
  s_cmp_eq_u32 s70, s72
  s_cselect_b32 s70, s71, s70
  buffer_load_dwordx4 v232, s[8:11], s70 offen offset:0 lds
  v_mfma_f32_16x16x32_bf16 v[24:27], v[68:71], v[152:155], v[24:27]
  ds_read2_b32 v[56:57], v1 offset0:80 offset1:81
  v_mfma_f32_16x16x32_bf16 v[24:27], v[88:91], v[132:135], v[24:27]
  ds_read2_b32 v[58:59], v1 offset0:82 offset1:83
  v_mfma_f32_16x16x32_bf16 v[28:31], v[72:75], v[152:155], v[28:31]
  buffer_load_dwordx4 v233, s[8:11], s70 offen offset:1024 lds
  buffer_load_dwordx4 v234, s[8:11], s70 offen offset:2048 lds
  v_mfma_f32_16x16x32_bf16 v[28:31], v[88:91], v[136:139], v[28:31]
  ds_read_b128 v[124:127], v212 offset:3392
  v_mfma_f32_16x16x32_bf16 v[32:35], v[76:79], v[152:155], v[32:35]
  ds_read2_b32 v[60:61], v242 offset0:208 offset1:209
  v_mfma_f32_16x16x32_bf16 v[32:35], v[88:91], v[140:143], v[32:35]
  buffer_load_dwordx4 v235, s[8:11], s70 offen offset:3072 lds
  v_mfma_f32_16x16x32_bf16 v[168:171], a[72:75], v[224:227], v[168:171]
  v_mfma_f32_16x16x32_bf16 v[28:31], v[68:71], v[156:159], v[28:31]
  ds_read2_b32 v[62:63], v242 offset0:210 offset1:211
  v_mfma_f32_16x16x32_bf16 v[28:31], v[92:95], v[132:135], v[28:31]
  ds_read_b128 v[128:131], v212 offset:3904
  v_mfma_f32_16x16x32_bf16 v[32:35], v[72:75], v[156:159], v[32:35]
  v_mfma_f32_16x16x32_bf16 v[172:175], a[200:203], v[224:227], v[172:175]
  v_mfma_f32_16x16x32_bf16 v[168:171], a[76:79], v[224:227], v[168:171]
  v_mfma_f32_16x16x32_bf16 v[32:35], v[92:95], v[136:139], v[32:35]
  ds_read2_b32 v[64:65], v242 offset0:80 offset1:81
  v_mfma_f32_16x16x32_bf16 v[32:35], v[68:71], v[160:163], v[32:35]
  ds_read2_b32 v[66:67], v242 offset0:82 offset1:83
  v_mfma_f32_16x16x32_bf16 v[32:35], v[96:99], v[132:135], v[32:35]
  v_mfma_f32_16x16x32_bf16 v[172:175], a[204:207], v[224:227], v[172:175]
  s_waitcnt vmcnt(9)
  ds_read_b64_tr_b16 a[88:89], v252 offset:4096
  v_mfma_f32_16x16x32_bf16 v[4:7], v[36:39], v[100:103], v[4:7]
  ds_read_b128 v[132:135], v212 offset:256
  v_mfma_f32_16x16x32_bf16 v[8:11], v[36:39], v[104:107], v[8:11]
  ds_read2_b32 v[68:69], v3 offset0:192 offset1:193
  v_mfma_f32_16x16x32_bf16 v[8:11], v[40:43], v[100:103], v[8:11]
  ds_read_b64_tr_b16 a[90:91], v252 offset:5120
  ds_read_b64_tr_b16 a[216:217], v253 offset:4096
  v_mfma_f32_16x16x32_bf16 v[12:15], v[40:43], v[104:107], v[12:15]
  ds_read2_b32 v[70:71], v3 offset0:194 offset1:195
  v_mfma_f32_16x16x32_bf16 v[12:15], v[36:39], v[108:111], v[12:15]
  ds_read_b128 v[136:139], v212 offset:768
  v_mfma_f32_16x16x32_bf16 v[12:15], v[44:47], v[100:103], v[12:15]
  ds_read_b64_tr_b16 a[218:219], v253 offset:5120
  ds_read_b64_tr_b16 a[92:93], v252 offset:6144
  v_mfma_f32_16x16x32_bf16 v[16:19], v[40:43], v[108:111], v[16:19]
  ds_read2_b32 v[72:73], v3 offset0:64 offset1:65
  v_mfma_f32_16x16x32_bf16 v[16:19], v[44:47], v[104:107], v[16:19]
  ds_read2_b32 v[74:75], v3 offset0:66 offset1:67
  s_add_u32 s38, s27, 32768
  buffer_load_dwordx2 v[240:241], v247, s[60:63], s38 offen sc1
  v_mfma_f32_16x16x32_bf16 v[20:23], v[44:47], v[108:111], v[20:23]
  ds_read_b64_tr_b16 a[94:95], v252 offset:7168
  ds_read_b64_tr_b16 a[220:221], v253 offset:6144
  v_mfma_f32_16x16x32_bf16 v[16:19], v[36:39], v[112:115], v[16:19]
  ds_read_b128 v[140:143], v212 offset:1280
  v_mfma_f32_16x16x32_bf16 v[16:19], v[48:51], v[100:103], v[16:19]
  ds_read2_b32 v[76:77], v2 offset0:192 offset1:193
  v_mfma_f32_16x16x32_bf16 v[20:23], v[40:43], v[112:115], v[20:23]
  ds_read_b64_tr_b16 a[222:223], v253 offset:7168
  s_waitcnt lgkmcnt(0)
  s_add_u32 m0, s69, 4096
  s_add_u32 s70, s70, 114688
  s_cmp_eq_u32 s70, s72
  s_cselect_b32 s70, s71, s70
  v_mfma_f32_16x16x32_bf16 v[20:23], v[48:51], v[104:107], v[20:23]
  ds_read2_b32 v[78:79], v2 offset0:194 offset1:195
  v_mfma_f32_16x16x32_bf16 v[24:27], v[44:47], v[112:115], v[24:27]
  ds_read_b128 v[144:147], v212 offset:1792
  v_mfma_f32_16x16x32_bf16 v[24:27], v[48:51], v[108:111], v[24:27]
  buffer_load_dwordx4 v232, s[8:11], s70 offen offset:0 lds
  buffer_load_dwordx4 v233, s[8:11], s70 offen offset:1024 lds
  v_mfma_f32_16x16x32_bf16 v[28:31], v[48:51], v[112:115], v[28:31]
  ds_read2_b32 v[80:81], v2 offset0:64 offset1:65
  v_mfma_f32_16x16x32_bf16 v[20:23], v[36:39], v[116:119], v[20:23]
  ds_read2_b32 v[82:83], v2 offset0:66 offset1:67
  v_mfma_f32_16x16x32_bf16 v[20:23], v[52:55], v[100:103], v[20:23]
  buffer_load_dwordx4 v234, s[8:11], s70 offen offset:2048 lds
  buffer_load_dwordx4 v235, s[8:11], s70 offen offset:3072 lds
  v_mfma_f32_16x16x32_bf16 v[24:27], v[40:43], v[116:119], v[24:27]
  ds_read_b128 v[148:151], v212 offset:2304
  v_mfma_f32_16x16x32_bf16 v[24:27], v[52:55], v[104:107], v[24:27]
  ds_read2_b32 v[84:85], v1 offset0:192 offset1:193
  v_mfma_f32_16x16x32_bf16 v[28:31], v[44:47], v[116:119], v[28:31]
  v_mfma_f32_16x16x32_bf16 v[168:171], a[80:83], v[224:227], v[168:171]
  v_mfma_f32_16x16x32_bf16 v[172:175], a[208:211], v[224:227], v[172:175]
  v_mfma_f32_16x16x32_bf16 v[28:31], v[52:55], v[108:111], v[28:31]
  ds_read2_b32 v[86:87], v1 offset0:194 offset1:195
  v_mfma_f32_16x16x32_bf16 v[32:35], v[48:51], v[116:119], v[32:35]
  ds_read_b128 v[152:155], v212 offset:2816
  v_mfma_f32_16x16x32_bf16 v[32:35], v[52:55], v[112:115], v[32:35]
  v_mfma_f32_16x16x32_bf16 v[168:171], a[84:87], v[224:227], v[168:171]
  v_mfma_f32_16x16x32_bf16 v[172:175], a[212:215], v[224:227], v[172:175]
  v_mfma_f32_16x16x32_bf16 v[24:27], v[36:39], v[120:123], v[24:27]
  ds_read2_b32 v[88:89], v1 offset0:64 offset1:65
  v_mfma_f32_16x16x32_bf16 v[24:27], v[56:59], v[100:103], v[24:27]
  ds_read2_b32 v[90:91], v1 offset0:66 offset1:67
  v_mfma_f32_16x16x32_bf16 v[28:31], v[40:43], v[120:123], v[28:31]
  s_waitcnt vmcnt(9)
  ds_read_b64_tr_b16 a[96:97], v248 offset:0
  ds_read_b64_tr_b16 a[98:99], v248 offset:1024
  v_mfma_f32_16x16x32_bf16 v[28:31], v[56:59], v[104:107], v[28:31]
  ds_read_b128 v[156:159], v212 offset:3328
  v_mfma_f32_16x16x32_bf16 v[32:35], v[44:47], v[120:123], v[32:35]
  ds_read2_b32 v[92:93], v242 offset0:192 offset1:193
  v_mfma_f32_16x16x32_bf16 v[32:35], v[56:59], v[108:111], v[32:35]
  ds_read_b64_tr_b16 a[224:225], v249 offset:0
  ds_read_b64_tr_b16 a[226:227], v249 offset:1024
  v_mfma_f32_16x16x32_bf16 v[28:31], v[36:39], v[124:127], v[28:31]
  ds_read2_b32 v[94:95], v242 offset0:194 offset1:195
  v_mfma_f32_16x16x32_bf16 v[28:31], v[60:63], v[100:103], v[28:31]
  ds_read_b128 v[160:163], v212 offset:3840
  v_mfma_f32_16x16x32_bf16 v[32:35], v[40:43], v[124:127], v[32:35]
  ds_read_b64_tr_b16 a[100:101], v248 offset:2048
  ds_read_b64_tr_b16 a[102:103], v248 offset:3072
  v_mfma_f32_16x16x32_bf16 v[32:35], v[60:63], v[104:107], v[32:35]
  ds_read2_b32 v[96:97], v242 offset0:64 offset1:65
  v_mfma_f32_16x16x32_bf16 v[32:35], v[36:39], v[128:131], v[32:35]
  ds_read2_b32 v[98:99], v242 offset0:66 offset1:67
  v_mfma_f32_16x16x32_bf16 v[32:35], v[64:67], v[100:103], v[32:35]
  ds_read_b64_tr_b16 a[228:229], v249 offset:2048
  ds_read_b64_tr_b16 a[230:231], v249 offset:3072
  s_waitcnt lgkmcnt(0)
  s_add_u32 m0, s75, 0
  s_add_u32 s70, s70, 114688
  s_cmp_eq_u32 s70, s72
  s_cselect_b32 s70, s71, s70
  buffer_load_dwordx4 v232, s[8:11], s70 offen offset:0 lds
  buffer_load_dwordx4 v233, s[8:11], s70 offen offset:1024 lds
  buffer_load_dwordx4 v234, s[8:11], s70 offen offset:2048 lds
  buffer_load_dwordx4 v235, s[8:11], s70 offen offset:3072 lds
  v_mfma_f32_16x16x32_bf16 v[168:171], a[88:91], v[224:227], v[168:171]
  v_mfma_f32_16x16x32_bf16 v[172:175], a[216:219], v[224:227], v[172:175]
  v_mfma_f32_16x16x32_bf16 v[168:171], a[92:95], v[224:227], v[168:171]
  v_mfma_f32_16x16x32_bf16 v[172:175], a[220:223], v[224:227], v[172:175]
  s_waitcnt vmcnt(9)
  ds_read_b64_tr_b16 a[104:105], v252 offset:0
  ds_read_b64_tr_b16 a[106:107], v252 offset:1024
  ds_read_b64_tr_b16 a[232:233], v253 offset:0
  ds_read_b64_tr_b16 a[234:235], v253 offset:1024
  ds_read_b64_tr_b16 a[108:109], v252 offset:2048
  ds_read_b64_tr_b16 a[110:111], v252 offset:3072
  ds_read_b64_tr_b16 a[236:237], v253 offset:2048
  ds_read_b64_tr_b16 a[238:239], v253 offset:3072
  v_mfma_f32_16x16x32_bf16 v[168:171], a[96:99], v[224:227], v[168:171]
  v_mfma_f32_16x16x32_bf16 v[172:175], a[224:227], v[224:227], v[172:175]
  v_mfma_f32_16x16x32_bf16 v[168:171], a[100:103], v[224:227], v[168:171]
  v_mfma_f32_16x16x32_bf16 v[172:175], a[228:231], v[224:227], v[172:175]
  s_lshl_b32 s64, s73, 11
  s_add_u32 s64, s64, s51
  s_and_b32 s64, s64, 0x7fff
  s_xor_b32 s65, s64, 0x4000
  s_lshl_b32 s66, s3, 16
  s_add_u32 s64, s64, s66
  s_add_u32 s65, s65, s66
  s_waitcnt vmcnt(8)
  v_cmp_ne_u64 vcc, s[20:21], v[240:241]
  s_nop 4
  s_cbranch_vccz PK_8
  s_mov_b32 s25, 0
PL_9:
  buffer_load_dwordx2 v[240:241], v247, s[60:63], s38 offen sc1
  s_add_u32 s25, s25, 1
  s_waitcnt vmcnt(0)
  v_cmp_ne_u64 vcc, s[20:21], v[240:241]
  s_cmp_gt_u32 s25, 0x40000
  s_cbranch_scc1 PK_8
  s_nop 2
  s_cbranch_vccnz PL_9
PK_8:
  v_mfma_f32_16x16x32_bf16 v[4:7], v[68:71], v[132:135], v[4:7]
  s_add_u32 m0, s51, 0
  s_add_u32 s66, s64, 2097152
  buffer_load_dwordx4 v222, s[60:63], s66 offen offset:0 lds
  v_mfma_f32_16x16x32_bf16 v[8:11], v[68:71], v[136:139], v[8:11]
  buffer_load_dwordx4 v222, s[60:63], s66 offen offset:1024 lds
  buffer_load_dwordx4 v222, s[60:63], s66 offen offset:2048 lds
  v_mfma_f32_16x16x32_bf16 v[8:11], v[72:75], v[132:135], v[8:11]
  buffer_load_dwordx4 v222, s[60:63], s66 offen offset:3072 lds
  s_lshl_b32 s66, s41, 11
  s_add_u32 m0, s66, 86272
  s_lshl_b32 s34, s3, 13
  s_add_u32 s66, s66, s34
  s_add_u32 s66, s66, 18874368
  v_mfma_f32_16x16x32_bf16 v[12:15], v[72:75], v[136:139], v[12:15]
  buffer_load_dwordx4 v222, s[60:63], s66 offen offset:0 lds
  buffer_load_dwordx4 v222, s[60:63], s66 offen offset:1024 lds
  v_mfma_f32_16x16x32_bf16 v[12:15], v[68:71], v[140:143], v[12:15]
  s_add_u32 m0, s51, 16384
  s_add_u32 s66, s65, 2097152
  buffer_load_dwordx4 v222, s[60:63], s66 offen offset:0 lds
  v_mfma_f32_16x16x32_bf16 v[12:15], v[76:79], v[132:135], v[12:15]
  buffer_load_dwordx4 v222, s[60:63], s66 offen offset:1024 lds
  buffer_load_dwordx4 v222, s[60:63], s66 offen offset:2048 lds
  v_mfma_f32_16x16x32_bf16 v[16:19], v[72:75], v[140:143], v[16:19]
  buffer_load_dwordx4 v222, s[60:63], s66 offen offset:3072 lds
  v_mfma_f32_16x16x32_bf16 v[16:19], v[76:79], v[136:139], v[16:19]
  v_mfma_f32_16x16x32_bf16 v[20:23], v[76:79], v[140:143], v[20:23]
  v_mfma_f32_16x16x32_bf16 v[16:19], v[68:71], v[144:147], v[16:19]
  v_mfma_f32_16x16x32_bf16 v[16:19], v[80:83], v[132:135], v[16:19]
  v_mfma_f32_16x16x32_bf16 v[20:23], v[72:75], v[144:147], v[20:23]
  v_mfma_f32_16x16x32_bf16 v[20:23], v[80:83], v[136:139], v[20:23]
  v_mfma_f32_16x16x32_bf16 v[24:27], v[76:79], v[144:147], v[24:27]
  v_mfma_f32_16x16x32_bf16 v[24:27], v[80:83], v[140:143], v[24:27]
  v_mfma_f32_16x16x32_bf16 v[28:31], v[80:83], v[144:147], v[28:31]
  v_mfma_f32_16x16x32_bf16 v[20:23], v[68:71], v[148:151], v[20:23]
  s_waitcnt vmcnt(14)
  ds_read_b64_tr_b16 a[112:113], v252 offset:4096
  ds_read_b64_tr_b16 a[114:115], v252 offset:5120
  v_mfma_f32_16x16x32_bf16 v[20:23], v[84:87], v[132:135], v[20:23]
  ds_read_b64_tr_b16 a[240:241], v253 offset:4096
  ds_read_b64_tr_b16 a[242:243], v253 offset:5120
  v_mfma_f32_16x16x32_bf16 v[24:27], v[72:75], v[148:151], v[24:27]
  ds_read_b64_tr_b16 a[116:117], v252 offset:6144
  ds_read_b64_tr_b16 a[118:119], v252 offset:7168
  v_mfma_f32_16x16x32_bf16 v[24:27], v[84:87], v[136:139], v[24:27]
  ds_read_b64_tr_b16 a[244:245], v253 offset:6144
  ds_read_b64_tr_b16 a[246:247], v253 offset:7168
  v_mfma_f32_16x16x32_bf16 v[28:31], v[76:79], v[148:151], v[28:31]
  s_waitcnt lgkmcnt(14)
  v_mfma_f32_16x16x32_bf16 v[168:171], a[104:107], v[224:227], v[168:171]
  s_waitcnt lgkmcnt(12)
  v_mfma_f32_16x16x32_bf16 v[172:175], a[232:235], v[224:227], v[172:175]
  v_mfma_f32_16x16x32_bf16 v[28:31], v[84:87], v[140:143], v[28:31]
  s_waitcnt lgkmcnt(10)
  v_mfma_f32_16x16x32_bf16 v[168:171], a[108:111], v[224:227], v[168:171]
  s_waitcnt lgkmcnt(8)
  v_mfma_f32_16x16x32_bf16 v[172:175], a[236:239], v[224:227], v[172:175]
  v_mfma_f32_16x16x32_bf16 v[32:35], v[80:83], v[148:151], v[32:35]
  v_mfma_f32_16x16x32_bf16 v[32:35], v[84:87], v[144:147], v[32:35]
  v_mfma_f32_16x16x32_bf16 v[24:27], v[68:71], v[152:155], v[24:27]
  v_mfma_f32_16x16x32_bf16 v[24:27], v[88:91], v[132:135], v[24:27]
  v_mfma_f32_16x16x32_bf16 v[28:31], v[72:75], v[152:155], v[28:31]
  v_mfma_f32_16x16x32_bf16 v[28:31], v[88:91], v[136:139], v[28:31]
  v_mfma_f32_16x16x32_bf16 v[32:35], v[76:79], v[152:155], v[32:35]
  s_waitcnt vmcnt(10)
  ds_read_b64_tr_b16 a[120:121], v248 offset:0
  ds_read_b64_tr_b16 a[122:123], v248 offset:1024
  v_mfma_f32_16x16x32_bf16 v[32:35], v[88:91], v[140:143], v[32:35]
  ds_read_b64_tr_b16 a[248:249], v249 offset:0
  ds_read_b64_tr_b16 a[250:251], v249 offset:1024
  v_mfma_f32_16x16x32_bf16 v[28:31], v[68:71], v[156:159], v[28:31]
  ds_read_b64_tr_b16 a[124:125], v248 offset:2048
  ds_read_b64_tr_b16 a[126:127], v248 offset:3072
  v_mfma_f32_16x16x32_bf16 v[28:31], v[92:95], v[132:135], v[28:31]
  ds_read_b64_tr_b16 a[252:253], v249 offset:2048
  ds_read_b64_tr_b16 a[254:255], v249 offset:3072
  v_mfma_f32_16x16x32_bf16 v[32:35], v[72:75], v[156:159], v[32:35]
  s_waitcnt lgkmcnt(14)
  v_mfma_f32_16x16x32_bf16 v[168:171], a[112:115], v[224:227], v[168:171]
  s_waitcnt lgkmcnt(12)
  v_mfma_f32_16x16x32_bf16 v[172:175], a[240:243], v[224:227], v[172:175]
  v_mfma_f32_16x16x32_bf16 v[32:35], v[92:95], v[136:139], v[32:35]
  s_waitcnt lgkmcnt(10)
  v_mfma_f32_16x16x32_bf16 v[168:171], a[116:119], v[224:227], v[168:171]
  s_waitcnt lgkmcnt(8)
  v_mfma_f32_16x16x32_bf16 v[172:175], a[244:247], v[224:227], v[172:175]
  v_mfma_f32_16x16x32_bf16 v[32:35], v[68:71], v[160:163], v[32:35]
  v_mfma_f32_16x16x32_bf16 v[32:35], v[96:99], v[132:135], v[32:35]
  s_waitcnt lgkmcnt(6)
  v_mfma_f32_16x16x32_bf16 v[168:171], a[120:123], v[224:227], v[168:171]
  s_waitcnt lgkmcnt(4)
  v_mfma_f32_16x16x32_bf16 v[172:175], a[248:251], v[224:227], v[172:175]
  s_waitcnt lgkmcnt(2)
  v_mfma_f32_16x16x32_bf16 v[168:171], a[124:127], v[224:227], v[168:171]
  s_waitcnt lgkmcnt(0)
  v_mfma_f32_16x16x32_bf16 v[172:175], a[252:255], v[224:227], v[172:175]
  s_mul_i32 s34, s43, 5088
  s_lshl_b32 s35, s42, 11
  s_add_u32 s34, s34, s35
  s_add_u32 s34, s34, 153056
  v_add_u32 v180, s34, v179
  ds_read_b64 v[36:37], v180 offset:0
  ds_read_b64 v[38:39], v180 offset:512
  ds_read_b64 v[40:41], v180 offset:1024
  ds_read_b64 v[42:43], v180 offset:1536
  s_mul_i32 s26, s50, 4224
  s_add_u32 s26, s26, s35
  s_add_u32 s26, s26, 15728640
  v_add_u32 v76, s69, v222
  s_xor_b32 s34, s41, 1
  s_lshl_b32 s34, s34, 13
  s_add_u32 s34, s34, 102912
  s_add_u32 m0, s51, 32768
  s_add_u32 s66, s64, 2129920
  v_add_u32 v77, s34, v222
  v_add_u32 v78, s69, v179
  s_cmp_eq_u32 s42, 0
  s_cselect_b64 vcc, -1, 0
  v_cndmask_b32 v60, v20, v4, vcc
  v_cndmask_b32 v4, v4, v20, vcc
  v_cndmask_b32 v61, v21, v5, vcc
  v_cndmask_b32 v5, v5, v21, vcc
  buffer_load_dwordx4 v222, s[60:63], s66 offen offset:0 lds
  v_cndmask_b32 v62, v22, v6, vcc
  v_cndmask_b32 v6, v6, v22, vcc
  v_cndmask_b32 v63, v23, v7, vcc
  v_cndmask_b32 v7, v7, v23, vcc
  v_cndmask_b32 v64, v24, v8, vcc
  v_cndmask_b32 v8, v8, v24, vcc
  v_cndmask_b32 v65, v25, v9, vcc
  buffer_load_dwordx4 v222, s[60:63], s66 offen offset:1024 lds
  v_cndmask_b32 v9, v9, v25, vcc
  v_cndmask_b32 v66, v26, v10, vcc
  v_cndmask_b32 v10, v10, v26, vcc
  v_cndmask_b32 v67, v27, v11, vcc
  v_cndmask_b32 v11, v11, v27, vcc
  v_cndmask_b32 v68, v28, v12, vcc
  v_cndmask_b32 v12, v12, v28, vcc
  buffer_load_dwordx4 v222, s[60:63], s66 offen offset:2048 lds
  v_cndmask_b32 v69, v29, v13, vcc
  v_cndmask_b32 v13, v13, v29, vcc
  v_cndmask_b32 v70, v30, v14, vcc
  v_cndmask_b32 v14, v14, v30, vcc
  v_cndmask_b32 v71, v31, v15, vcc
  v_cndmask_b32 v15, v15, v31, vcc
  v_cndmask_b32 v72, v32, v16, vcc
  buffer_load_dwordx4 v222, s[60:63], s66 offen offset:3072 lds
  v_cndmask_b32 v16, v16, v32, vcc
  v_cndmask_b32 v73, v33, v17, vcc
  v_cndmask_b32 v17, v17, v33, vcc
  v_cndmask_b32 v74, v34, v18, vcc
  v_cndmask_b32 v18, v18, v34, vcc
  v_cndmask_b32 v75, v35, v19, vcc
  v_cndmask_b32 v19, v19, v35, vcc
  s_add_u32 m0, s51, 49152
  s_add_u32 s66, s65, 2129920
  s_waitcnt lgkmcnt(3)
  v_lshlrev_b32 v44, 16, v36
  v_and_b32 v45, 0xffff0000, v36
  v_lshlrev_b32 v46, 16, v37
  v_and_b32 v47, 0xffff0000, v37
  s_waitcnt lgkmcnt(2)
  v_lshlrev_b32 v48, 16, v38
  v_and_b32 v49, 0xffff0000, v38
  v_lshlrev_b32 v50, 16, v39
  buffer_load_dwordx4 v222, s[60:63], s66 offen offset:0 lds
  v_and_b32 v51, 0xffff0000, v39
  s_waitcnt lgkmcnt(1)
  v_lshlrev_b32 v52, 16, v40
  v_and_b32 v53, 0xffff0000, v40
  v_lshlrev_b32 v54, 16, v41
  v_and_b32 v55, 0xffff0000, v41
  s_waitcnt lgkmcnt(0)
  v_lshlrev_b32 v56, 16, v42
  v_and_b32 v57, 0xffff0000, v42
  buffer_load_dwordx4 v222, s[60:63], s66 offen offset:1024 lds
  v_lshlrev_b32 v58, 16, v43
  v_and_b32 v59, 0xffff0000, v43
  v_pk_fma_f32 v[60:61], v[44:45], v[250:251], v[60:61] op_sel:[0,1,0] op_sel_hi:[1,1,1]
  v_pk_fma_f32 v[62:63], v[46:47], v[250:251], v[62:63] op_sel:[0,1,0] op_sel_hi:[1,1,1]
  v_pk_fma_f32 v[64:65], v[48:49], v[250:251], v[64:65] op_sel:[0,1,0] op_sel_hi:[1,1,1]
  v_pk_fma_f32 v[66:67], v[50:51], v[250:251], v[66:67] op_sel:[0,1,0] op_sel_hi:[1,1,1]
  v_pk_fma_f32 v[68:69], v[52:53], v[250:251], v[68:69] op_sel:[0,1,0] op_sel_hi:[1,1,1]
  buffer_load_dwordx4 v222, s[60:63], s66 offen offset:2048 lds
  v_pk_fma_f32 v[70:71], v[54:55], v[250:251], v[70:71] op_sel:[0,1,0] op_sel_hi:[1,1,1]
  v_pk_fma_f32 v[72:73], v[56:57], v[250:251], v[72:73] op_sel:[0,1,0] op_sel_hi:[1,1,1]
  v_pk_fma_f32 v[74:75], v[58:59], v[250:251], v[74:75] op_sel:[0,1,0] op_sel_hi:[1,1,1]
  buffer_load_dwordx4 v222, s[60:63], s66 offen offset:3072 lds
  ds_write_b128 v76, v[4:7]  offset:0
  ds_write_b128 v76, v[8:11]  offset:1024
  ds_write_b128 v76, v[12:15]  offset:2048
  ds_write_b128 v76, v[16:19]  offset:3072
  s_mov_b32 exec_lo, 0x01010101
  s_mov_b32 exec_hi, 0x01010101
  ds_write_b128 v228, v[168:171]
  ds_write_b128 v228, v[172:175] offset:128
  s_mov_b64 exec, -1
  s_lshl_b32 s34, s41, 8
  s_add_u32 s34, s34, 67584
  v_lshl_add_u32 v181, v229, 2, s34
  ds_read_b32 v182, v181
  ds_read_b32 v183, v181 offset:128
  s_add_u32 s74, s51, 69632
  s_add_u32 s75, s51, 135680
  s_cmp_lt_u32 s41, 2
  s_cselect_b32 s76, 0, 49408
  s_add_u32 s76, s76, s51
  s_add_u32 s76, s76, 94464
  s_lshl_b32 s71, s41, 13
  s_add_u32 s77, s71, 102912
  s_mul_i32 s69, s41, 57344
  s_lshl_b32 s34, s40, 18
  s_add_u32 s34, s34, 20971520
  s_add_u32 s69, s69, s34
  s_lshl_b32 s34, s42, 6
  v_xor_b32 v231, s34, v231
  s_mul_i32 s82, s3, 229376
  s_mul_i32 s34, s40, 14336
  s_add_u32 s82, s82, s34
  s_add_u32 s82, s82, s51
  s_add_u32 s82, s82, 4194304
  s_cmp_eq_u32 s41, 3
  s_cselect_b32 s34, 0x80000000, 0
  v_or_b32 v252, s34, v222
  v_lshlrev_b32 v180, 2, v255
  v_add_u32 v180, 86272, v180
  s_lshl_b32 s39, s3, 3
  s_add_u32 s39, s39, s32
  s_add_u32 s39, s39, 32768
  s_waitcnt lgkmcnt(1)
  v_cvt_pk_bf16_f32 v20, v182, v182
  v_mov_b32 v22, 0
  v_and_b32 v184, 0xffff0000, v20
  v_mov_b32 v23, 0
  v_sub_f32 v184, v182, v184
  v_mov_b32 v30, 0
  v_cvt_pk_bf16_f32 v21, v184, 0
  v_mov_b32 v31, 0
  s_waitcnt lgkmcnt(0)
  v_cvt_pk_bf16_f32 v24, v183, v183
  v_mov_b32 v26, 0
  v_and_b32 v184, 0xffff0000, v24
  v_mov_b32 v27, 0
  v_sub_f32 v184, v183, v184
  v_mov_b32 v34, 0
  v_cvt_pk_bf16_f32 v25, v184, 0
  v_mov_b32 v35, 0
  s_waitcnt vmcnt(12)
  s_barrier
  ds_read_b128 v[96:99], v222 offset:0
  ds_read_b128 v[100:103], v222 offset:1024
  ds_read_b128 v[104:107], v222 offset:2048
  ds_read_b128 v[108:111], v222 offset:3072
  ds_read_b128 v[112:115], v222 offset:4096
  ds_read_b128 v[116:119], v222 offset:5120
  ds_read_b128 v[120:123], v222 offset:6144
  s_waitcnt lgkmcnt(3)
  v_mfma_f32_32x32x16_bf16 v[44:59], a[0:3], v[96:99], 0
  ds_read_b128 v[124:127], v222 offset:7168
  ds_read2st64_b32 v[144:145], v180 offset0:0 offset1:1
  ds_read2st64_b32 v[146:147], v180 offset0:2 offset1:3
  ds_read2st64_b32 v[148:149], v180 offset0:4 offset1:5
  ds_read2st64_b32 v[150:151], v180 offset0:6 offset1:7
  v_mfma_f32_32x32x16_bf16 v[44:59], a[4:7], v[100:103], v[44:59]
  ds_read_b128 v[96:99], v222 offset:8192
  ds_read2st64_b32 v[152:153], v180 offset0:8 offset1:9
  ds_read2st64_b32 v[154:155], v180 offset0:10 offset1:11
  ds_read2st64_b32 v[156:157], v180 offset0:12 offset1:13
  ds_read2st64_b32 v[158:159], v180 offset0:14 offset1:15
  ds_read2st64_b32 v[160:161], v180 offset0:16 offset1:17
  v_mfma_f32_32x32x16_bf16 v[44:59], a[8:11], v[104:107], v[44:59]
  ds_read_b128 v[100:103], v222 offset:9216
  ds_read2st64_b32 v[162:163], v180 offset0:18 offset1:19
  ds_read2st64_b32 v[164:165], v180 offset0:20 offset1:21
  ds_read2st64_b32 v[166:167], v180 offset0:22 offset1:23
  ds_read2st64_b32 v[168:169], v180 offset0:24 offset1:25
  ds_read2st64_b32 v[170:171], v180 offset0:26 offset1:27
  v_mfma_f32_32x32x16_bf16 v[44:59], a[12:15], v[108:111], v[44:59]
  ds_read_b128 v[104:107], v222 offset:10240
  ds_read2st64_b32 v[172:173], v180 offset0:28 offset1:29
  ds_read2st64_b32 v[174:175], v180 offset0:30 offset1:31
  ds_read_b128 v[4:7], v77 offset:0
  ds_read_b128 v[8:11], v77 offset:1024
  ds_read_b128 v[12:15], v77 offset:2048
  s_waitcnt lgkmcnt(15)
  v_mfma_f32_32x32x16_bf16 v[44:59], a[16:19], v[112:115], v[44:59]
  ds_read_b128 v[108:111], v222 offset:11264
  ds_read_b128 v[16:19], v77 offset:3072
  s_waitcnt lgkmcnt(4)
  v_add_f32 v60, v60, v4
  v_add_f32 v61, v61, v5
  v_add_f32 v62, v62, v6
  v_mfma_f32_32x32x16_bf16 v[44:59], a[20:23], v[116:119], v[44:59]
  ds_read_b128 v[112:115], v222 offset:12288
  v_add_f32 v63, v63, v7
  s_waitcnt lgkmcnt(4)
  v_add_f32 v64, v64, v8
  v_add_f32 v65, v65, v9
  v_add_f32 v66, v66, v10
  v_add_f32 v67, v67, v11
  v_mfma_f32_32x32x16_bf16 v[44:59], a[24:27], v[120:123], v[44:59]
  ds_read_b128 v[116:119], v222 offset:13312
  s_waitcnt lgkmcnt(4)
  v_add_f32 v68, v68, v12
  v_add_f32 v69, v69, v13
  v_add_f32 v70, v70, v14
  v_add_f32 v71, v71, v15
  s_waitcnt lgkmcnt(2)
  v_add_f32 v72, v72, v16
  v_mfma_f32_32x32x16_bf16 v[44:59], a[28:31], v[124:127], v[44:59]
  ds_read_b128 v[120:123], v222 offset:14336
  v_add_f32 v73, v73, v17
  v_add_f32 v74, v74, v18
  v_add_f32 v75, v75, v19
  v_cvt_pk_bf16_f32 v36, v60, v61
  v_cvt_pk_bf16_f32 v37, v62, v63
  v_mfma_f32_32x32x16_bf16 v[44:59], a[32:35], v[96:99], v[44:59]
  ds_read_b128 v[124:127], v222 offset:15360
  s_add_u32 m0, s74, 0
  s_add_u32 s68, s69, 4096
  v_cvt_pk_bf16_f32 v38, v64, v65
  v_cvt_pk_bf16_f32 v39, v66, v67
  s_waitcnt vmcnt(8)
  s_barrier
  v_mfma_f32_32x32x16_bf16 v[44:59], a[36:39], v[100:103], v[44:59]
  ds_read_b128 v[96:99], v222 offset:16384
  buffer_load_dwordx4 v222, s[60:63], s68 offen offset:0 lds
  v_cvt_pk_bf16_f32 v40, v68, v69
  v_mfma_f32_32x32x16_bf16 v[44:59], a[40:43], v[104:107], v[44:59]
  ds_read_b128 v[100:103], v222 offset:17408
  buffer_load_dwordx4 v222, s[60:63], s68 offen offset:1024 lds
  v_cvt_pk_bf16_f32 v41, v70, v71
  v_cvt_pk_bf16_f32 v42, v72, v73
  v_cvt_pk_bf16_f32 v43, v74, v75
  v_mfma_f32_32x32x16_bf16 v[44:59], a[44:47], v[108:111], v[44:59]
  ds_read_b128 v[104:107], v222 offset:18432
  ds_write_b64 v78, v[36:37] offset:4096
  ds_write_b64 v78, v[38:39] offset:4608
  ds_write_b64 v78, v[40:41] offset:5120
  ds_write_b64 v78, v[42:43] offset:5632
  ds_read_b128 v[36:39], v76 offset:4096
  s_waitcnt lgkmcnt(8)
  v_mfma_f32_32x32x16_bf16 v[44:59], a[48:51], v[112:115], v[44:59]
  ds_read_b128 v[108:111], v222 offset:19456
  buffer_load_dwordx4 v222, s[60:63], s68 offen offset:2048 lds
  ds_read_b128 v[40:43], v76 offset:5120
  s_waitcnt lgkmcnt(2)
  buffer_store_dwordx4 v[36:39], v222, s[60:63], s26 offen offset:0 sc1
  v_mfma_f32_32x32x16_bf16 v[44:59], a[52:55], v[116:119], v[44:59]
  ds_read_b128 v[112:115], v222 offset:20480
  s_waitcnt lgkmcnt(1)
  buffer_store_dwordx4 v[40:43], v222, s[60:63], s26 offen offset:1024 sc1
  s_lshl_b32 s78, s3, 9
  s_add_u32 s78, s78, 18350080
  s_lshl_b32 s72, s41, 7
  s_add_u32 s79, s78, s72
  v_mfma_f32_32x32x16_bf16 v[44:59], a[56:59], v[120:123], v[44:59]
  ds_read_b128 v[116:119], v222 offset:21504
  s_lshr_b32 s72, s40, 1
  s_lshl_b32 s72, s72, 7
  s_add_u32 s78, s78, s72
  s_and_b32 s72, s40, 1
  s_lshl_b32 s72, s72, 3
  v_mfma_f32_32x32x16_bf16 v[44:59], a[60:63], v[124:127], v[44:59]
  ds_read_b128 v[120:123], v222 offset:22528
  s_add_u32 s78, s78, s72
  v_and_b32 v251, 1, v255
  v_lshlrev_b32 v251, 3, v251
  s_mul_i32 s80, s3, 229376
  s_mul_i32 s72, s41, 28672
  v_mfma_f32_32x32x16_bf16 v[44:59], a[64:67], v[96:99], v[44:59]
  ds_read_b128 v[124:127], v222 offset:23552
  buffer_load_dwordx4 v222, s[60:63], s68 offen offset:3072 lds
  s_add_u32 s80, s80, s72
  s_add_u32 s80, s80, 4194304
  v_mfma_f32_32x32x16_bf16 v[44:59], a[68:71], v[100:103], v[44:59]
  ds_read_b128 v[96:99], v222 offset:24576
  s_add_u32 m0, s75, 0
  s_add_u32 s68, s69, 12288
  v_add_u32 v253, 114688, v222
  v_add_f32 v144, v144, v160
  v_add_f32 v145, v145, v161
  v_mfma_f32_32x32x16_bf16 v[44:59], a[72:75], v[104:107], v[44:59]
  ds_read_b128 v[100:103], v222 offset:25600
  buffer_load_dwordx4 v222, s[60:63], s68 offen offset:0 lds
  v_add_f32 v146, v146, v162
  v_add_f32 v147, v147, v163
  v_add_f32 v148, v148, v164
  v_mfma_f32_32x32x16_bf16 v[44:59], a[76:79], v[108:111], v[44:59]
  ds_read_b128 v[104:107], v222 offset:26624
  v_add_f32 v149, v149, v165
  v_add_f32 v150, v150, v166
  v_add_f32 v151, v151, v167
  v_add_f32 v152, v152, v168
  v_add_f32 v153, v153, v169
  s_waitcnt lgkmcnt(3)
  v_mfma_f32_32x32x16_bf16 v[44:59], a[80:83], v[112:115], v[44:59]
  ds_read_b128 v[108:111], v222 offset:27648
  buffer_load_dwordx4 v222, s[60:63], s68 offen offset:1024 lds
  v_add_f32 v154, v154, v170
  v_add_f32 v155, v155, v171
  v_mfma_f32_32x32x16_bf16 v[44:59], a[84:87], v[116:119], v[44:59]
  ds_read_b128 v[112:115], v222 offset:28672
  v_add_f32 v156, v156, v172
  v_add_f32 v157, v157, v173
  v_add_f32 v158, v158, v174
  v_add_f32 v159, v159, v175
  v_add_f32 v144, v144, v152
  v_mfma_f32_32x32x16_bf16 v[44:59], a[88:91], v[120:123], v[44:59]
  ds_read_b128 v[116:119], v222 offset:29696
  buffer_load_dwordx4 v222, s[60:63], s68 offen offset:2048 lds
  v_add_f32 v145, v145, v153
  v_add_f32 v146, v146, v154
  v_add_f32 v147, v147, v155
  v_mfma_f32_32x32x16_bf16 v[44:59], a[92:95], v[124:127], v[44:59]
  ds_read_b128 v[120:123], v222 offset:30720
  v_add_f32 v148, v148, v156
  v_add_f32 v149, v149, v157
  v_add_f32 v150, v150, v158
  v_add_f32 v151, v151, v159
  v_add_f32 v144, v144, v148
  s_waitcnt lgkmcnt(3)
  v_mfma_f32_32x32x16_bf16 v[44:59], a[96:99], v[96:99], v[44:59]
  ds_read_b128 v[124:127], v222 offset:31744
  buffer_load_dwordx4 v222, s[60:63], s68 offen offset:3072 lds
  v_add_f32 v145, v145, v149
  v_add_f32 v146, v146, v150
  s_waitcnt vmcnt(14)
  s_barrier
  v_mfma_f32_32x32x16_bf16 v[44:59], a[100:103], v[100:103], v[44:59]
  ds_read_b128 v[96:99], v222 offset:32768
  s_add_u32 m0, s76, 0
  s_add_u32 s68, s69, 20480
  v_add_f32 v147, v147, v151
  v_mfma_f32_32x32x16_bf16 v[44:59], a[104:107], v[104:107], v[44:59]
  ds_read_b128 v[100:103], v222 offset:33792
  buffer_load_dwordx4 v222, s[60:63], s68 offen offset:0 lds
  v_add_f32 v144, v144, v146
  v_add_f32 v145, v145, v147
  v_mov_b32 v146, v144
  v_mfma_f32_32x32x16_bf16 v[44:59], a[108:111], v[108:111], v[44:59]
  ds_read_b128 v[104:107], v222 offset:34816
  v_mov_b32 v147, v145
  v_cmp_gt_u32 vcc, 32, v255
  v_permlane32_swap_b32 v144, v146
  v_permlane32_swap_b32 v145, v147
  v_mul_f32 v144, s45, v144
  s_waitcnt lgkmcnt(3)
  v_mfma_f32_32x32x16_bf16 v[44:59], a[112:115], v[112:115], v[44:59]
  ds_read_b128 v[108:111], v222 offset:35840
  buffer_load_dwordx4 v222, s[60:63], s68 offen offset:1024 lds
  v_mul_f32 v145, s45, v145
  v_mul_f32 v148, v144, v144
  v_mfma_f32_32x32x16_bf16 v[44:59], a[116:119], v[116:119], v[44:59]
  ds_read_b128 v[112:115], v222 offset:36864
  v_mul_f32 v149, v145, v145
  v_fma_f32 v146, v146, s45, -v148
  v_fma_f32 v147, v147, s45, -v149
  v_cndmask_b32 v144, 0, -v144, vcc
  v_cndmask_b32 v145, 0, -v145, vcc
  v_mfma_f32_32x32x16_bf16 v[44:59], a[120:123], v[120:123], v[44:59]
  ds_read_b128 v[116:119], v222 offset:37888
  buffer_load_dwordx4 v222, s[60:63], s68 offen offset:2048 lds
  v_max_f32 v146, 0, v146
  v_max_f32 v147, 0, v147
  v_cvt_pk_bf16_f32 v29, v144, 0
  v_mfma_f32_32x32x16_bf16 v[44:59], a[124:127], v[124:127], v[44:59]
  ds_read_b128 v[120:123], v222 offset:38912
  v_cvt_pk_bf16_f32 v33, v145, 0
  v_add_f32 v146, s46, v146
  v_add_f32 v147, s46, v147
  v_lshlrev_b32 v152, 16, v29
  v_lshlrev_b32 v153, 16, v33
  v_rsq_f32 v148, v146
  v_rsq_f32 v149, v147
  v_sub_f32 v152, v144, v152
  v_sub_f32 v153, v145, v153
  v_log_f32 v212, v146
  v_log_f32 v213, v147
  v_cvt_pk_bf16_f32 v28, v144, v152
  v_cvt_pk_bf16_f32 v32, v145, v153
  v_mul_f32 v2, v146, v148
  v_mul_f32 v3, v147, v149
  v_mul_f32 v176, s47, v148
  v_mul_f32 v177, s47, v149
  v_mul_f32 v150, v148, v148
  v_mul_f32 v151, v149, v149
  v_mul_f32 v212, 0.5, v212
  v_mul_f32 v213, 0.5, v213
  v_mul_f32 v150, v150, v148
  v_mul_f32 v151, v151, v149
  v_mul_f32 v178, s48, v150
  v_mul_f32 v179, s48, v151
  v_mfma_f32_32x32x16_bf16 v[44:59], v[20:23], v[28:31], v[44:59]
  s_waitcnt lgkmcnt(3)
  v_mfma_f32_32x32x16_bf16 v[80:95], a[0:3], v[96:99], 0
  ds_read_b128 v[124:127], v222 offset:39936
  v_add_u32 v250, s74, v222
  v_add_u32 v249, s75, v222
  v_add_u32 v248, s76, v222
  v_add_u32 v242, s77, v222
  v_add_u32 v241, s71, v222
  buffer_load_dwordx4 v222, s[60:63], s68 offen offset:3072 lds
  v_mfma_f32_32x32x16_bf16 v[80:95], a[4:7], v[100:103], v[80:95]
  ds_read_b128 v[96:99], v222 offset:40960
  s_add_u32 s68, s69, 0
  v_mfma_f32_32x32x16_bf16 v[80:95], a[8:11], v[104:107], v[80:95]
  ds_read_b128 v[100:103], v222 offset:41984
  buffer_load_dwordx4 v[4:7], v222, s[60:63], s68 offen offset:0
  v_mul_f32 v128, v44, v44
  v_mul_f32 v129, v45, v45
  v_mul_f32 v130, v46, v46
  v_mul_f32 v131, v47, v47
  v_mfma_f32_32x32x16_bf16 v[80:95], a[12:15], v[108:111], v[80:95]
  ds_read_b128 v[104:107], v222 offset:43008
  v_fma_f32 v128, v128, v178, v176
  v_fma_f32 v129, v129, v178, v176
  v_fma_f32 v130, v130, v178, v176
  v_fma_f32 v131, v131, v178, v176
  v_fma_f32 v128, v128, v44, v212
  s_waitcnt lgkmcnt(3)
  v_mfma_f32_32x32x16_bf16 v[80:95], a[16:19], v[112:115], v[80:95]
  ds_read_b128 v[108:111], v222 offset:44032
  buffer_load_dwordx4 v[8:11], v222, s[60:63], s68 offen offset:1024
  v_fma_f32 v129, v129, v45, v212
  v_fma_f32 v130, v130, v46, v212
  v_mfma_f32_32x32x16_bf16 v[80:95], a[20:23], v[116:119], v[80:95]
  ds_read_b128 v[112:115], v222 offset:45056
  v_fma_f32 v131, v131, v47, v212
  v_exp_f32 v128, v128
  v_exp_f32 v129, v129
  v_mfma_f32_32x32x16_bf16 v[80:95], a[24:27], v[120:123], v[80:95]
  ds_read_b128 v[116:119], v222 offset:46080
  buffer_load_dwordx4 v[12:15], v222, s[60:63], s68 offen offset:2048
  v_exp_f32 v130, v130
  v_mfma_f32_32x32x16_bf16 v[80:95], a[28:31], v[124:127], v[80:95]
  ds_read_b128 v[120:123], v222 offset:47104
  v_exp_f32 v131, v131
  v_add_f32 v128, v128, v2
  v_add_f32 v129, v129, v2
  v_add_f32 v130, v130, v2
  v_add_f32 v131, v131, v2
  s_waitcnt lgkmcnt(3)
  v_mfma_f32_32x32x16_bf16 v[80:95], a[32:35], v[96:99], v[80:95]
  ds_read_b128 v[124:127], v222 offset:48128
  buffer_load_dwordx4 v[16:19], v222, s[60:63], s68 offen offset:3072
  v_rcp_f32 v128, v128
  s_waitcnt vmcnt(18)
  s_barrier
  v_mfma_f32_32x32x16_bf16 v[80:95], a[36:39], v[100:103], v[80:95]
  ds_read_b128 v[96:99], v222 offset:49152
  s_add_u32 s68, s69, 8192
  v_rcp_f32 v129, v129
  v_mfma_f32_32x32x16_bf16 v[80:95], a[40:43], v[104:107], v[80:95]
  ds_read_b128 v[100:103], v222 offset:50176
  buffer_load_dwordx4 v[36:39], v222, s[60:63], s68 offen offset:0
  v_rcp_f32 v130, v130
  v_mfma_f32_32x32x16_bf16 v[80:95], a[44:47], v[108:111], v[80:95]
  ds_read_b128 v[104:107], v222 offset:51200
  v_rcp_f32 v131, v131
  v_mul_f32 v128, v128, v44
  v_mul_f32 v129, v129, v45
  v_mul_f32 v130, v130, v46
  v_mul_f32 v131, v131, v47
  s_waitcnt lgkmcnt(3)
  v_mfma_f32_32x32x16_bf16 v[80:95], a[48:51], v[112:115], v[80:95]
  ds_read_b128 v[108:111], v222 offset:52224
  buffer_load_dwordx4 v[40:43], v222, s[60:63], s68 offen offset:1024
  v_cvt_pk_bf16_f32 v136, v128, v129
  v_cvt_pk_bf16_f32 v137, v130, v131
  v_mfma_f32_32x32x16_bf16 v[80:95], a[52:55], v[116:119], v[80:95]
  ds_read_b128 v[112:115], v222 offset:53248
  v_mul_f32 v132, v48, v48
  v_mul_f32 v133, v49, v49
  v_mul_f32 v134, v50, v50
  v_mul_f32 v135, v51, v51
  v_fma_f32 v132, v132, v178, v176
  v_mfma_f32_32x32x16_bf16 v[80:95], a[56:59], v[120:123], v[80:95]
  ds_read_b128 v[116:119], v222 offset:54272
  buffer_load_dwordx4 v[60:63], v222, s[60:63], s68 offen offset:2048
  v_fma_f32 v133, v133, v178, v176
  v_fma_f32 v134, v134, v178, v176
  v_fma_f32 v135, v135, v178, v176
  v_mfma_f32_32x32x16_bf16 v[80:95], a[60:63], v[124:127], v[80:95]
  ds_read_b128 v[120:123], v222 offset:55296
  v_fma_f32 v132, v132, v48, v212
  v_fma_f32 v133, v133, v49, v212
  v_fma_f32 v134, v134, v50, v212
  v_fma_f32 v135, v135, v51, v212
  s_waitcnt lgkmcnt(3)
  v_mfma_f32_32x32x16_bf16 v[80:95], a[64:67], v[96:99], v[80:95]
  ds_read_b128 v[124:127], v222 offset:56320
  buffer_load_dwordx4 v[64:67], v222, s[60:63], s68 offen offset:3072
  v_exp_f32 v132, v132
  v_mfma_f32_32x32x16_bf16 v[80:95], a[68:71], v[100:103], v[80:95]
  ds_read_b128 v[96:99], v222 offset:57344
  s_add_u32 s68, s69, 16384
  v_exp_f32 v133, v133
  v_exp_f32 v134, v134
  v_mfma_f32_32x32x16_bf16 v[80:95], a[72:75], v[104:107], v[80:95]
  ds_read_b128 v[100:103], v222 offset:58368
  buffer_load_dwordx4 v[68:71], v222, s[60:63], s68 offen offset:0
  v_exp_f32 v135, v135
  v_add_f32 v132, v132, v2
  v_add_f32 v133, v133, v2
  v_mfma_f32_32x32x16_bf16 v[80:95], a[76:79], v[108:111], v[80:95]
  ds_read_b128 v[104:107], v222 offset:59392
  v_add_f32 v134, v134, v2
  v_add_f32 v135, v135, v2
  v_rcp_f32 v132, v132
  s_waitcnt lgkmcnt(3)
  v_mfma_f32_32x32x16_bf16 v[80:95], a[80:83], v[112:115], v[80:95]
  ds_read_b128 v[108:111], v222 offset:60416
  buffer_load_dwordx4 v[72:75], v222, s[60:63], s68 offen offset:1024
  v_rcp_f32 v133, v133
  v_mfma_f32_32x32x16_bf16 v[80:95], a[84:87], v[116:119], v[80:95]
  ds_read_b128 v[112:115], v222 offset:61440
  v_rcp_f32 v134, v134
  v_rcp_f32 v135, v135
  v_mul_f32 v132, v132, v48
  v_mul_f32 v133, v133, v49
  v_mfma_f32_32x32x16_bf16 v[80:95], a[88:91], v[120:123], v[80:95]
  ds_read_b128 v[116:119], v222 offset:62464
  buffer_load_dwordx4 v[76:79], v222, s[60:63], s68 offen offset:2048
  v_mul_f32 v134, v134, v50
  v_mul_f32 v135, v135, v51
  v_cvt_pk_bf16_f32 v138, v132, v133
  v_mfma_f32_32x32x16_bf16 v[80:95], a[92:95], v[124:127], v[80:95]
  ds_read_b128 v[120:123], v222 offset:63488
  v_cvt_pk_bf16_f32 v139, v134, v135
  s_add_u32 s37, s82, 0
  s_waitcnt lgkmcnt(3)
  v_mfma_f32_32x32x16_bf16 v[80:95], a[96:99], v[96:99], v[80:95]
  ds_read_b128 v[124:127], v222 offset:64512
  buffer_load_dwordx4 v[144:147], v222, s[60:63], s68 offen offset:3072
  v_mfma_f32_32x32x16_bf16 v[80:95], a[100:103], v[100:103], v[80:95]
  ds_read_b128 v[96:99], v222 offset:0
  s_add_u32 s68, s69, 24576
  buffer_store_dwordx4 v[136:139], v222, s[60:63], s37 offen offset:0 sc1
  v_mul_f32 v128, v52, v52
  v_mfma_f32_32x32x16_bf16 v[80:95], a[104:107], v[104:107], v[80:95]
  ds_read_b128 v[100:103], v222 offset:1024
  v_mul_f32 v129, v53, v53
  v_mul_f32 v130, v54, v54
  v_mul_f32 v131, v55, v55
  v_fma_f32 v128, v128, v178, v176
  v_fma_f32 v129, v129, v178, v176
  v_mfma_f32_32x32x16_bf16 v[80:95], a[108:111], v[108:111], v[80:95]
  ds_read_b128 v[104:107], v222 offset:2048
  v_fma_f32 v130, v130, v178, v176
  v_fma_f32 v131, v131, v178, v176
  v_fma_f32 v128, v128, v52, v212
  v_fma_f32 v129, v129, v53, v212
  v_fma_f32 v130, v130, v54, v212
  s_waitcnt lgkmcnt(3)
  v_mfma_f32_32x32x16_bf16 v[80:95], a[112:115], v[112:115], v[80:95]
  ds_read_b128 v[108:111], v222 offset:3072
  buffer_load_dwordx4 v[148:151], v222, s[60:63], s68 offen offset:0
  v_fma_f32 v131, v131, v55, v212
  v_mfma_f32_32x32x16_bf16 v[80:95], a[116:119], v[116:119], v[80:95]
  ds_read_b128 v[112:115], v222 offset:4096
  v_exp_f32 v128, v128
  v_exp_f32 v129, v129
  v_exp_f32 v130, v130
  v_mfma_f32_32x32x16_bf16 v[80:95], a[120:123], v[120:123], v[80:95]
  ds_read_b128 v[116:119], v222 offset:5120
  buffer_load_dwordx4 v[152:155], v222, s[60:63], s68 offen offset:1024
  v_exp_f32 v131, v131
  v_add_f32 v128, v128, v2
  v_mfma_f32_32x32x16_bf16 v[80:95], a[124:127], v[124:127], v[80:95]
  ds_read_b128 v[120:123], v222 offset:6144
  v_mfma_f32_32x32x16_bf16 v[80:95], v[20:23], v[32:35], v[80:95]
  v_add_f32 v129, v129, v2
  v_add_f32 v130, v130, v2
  v_add_f32 v131, v131, v2
  v_rcp_f32 v128, v128
  v_rcp_f32 v129, v129
  v_rcp_f32 v130, v130
  v_rcp_f32 v131, v131
  v_mul_f32 v128, v128, v52
  v_mul_f32 v129, v129, v53
  v_mul_f32 v130, v130, v54
  v_mul_f32 v131, v131, v55
  v_cvt_pk_bf16_f32 v140, v128, v129
  v_cvt_pk_bf16_f32 v141, v130, v131
  v_mul_f32 v132, v56, v56
  v_mul_f32 v133, v57, v57
  v_mul_f32 v134, v58, v58
  v_mul_f32 v135, v59, v59
  v_fma_f32 v132, v132, v178, v176
  v_fma_f32 v133, v133, v178, v176
  v_fma_f32 v134, v134, v178, v176
  v_fma_f32 v135, v135, v178, v176
  v_fma_f32 v132, v132, v56, v212
  v_fma_f32 v133, v133, v57, v212
  v_fma_f32 v134, v134, v58, v212
  v_fma_f32 v135, v135, v59, v212
  v_exp_f32 v132, v132
  v_exp_f32 v133, v133
  v_exp_f32 v134, v134
  v_exp_f32 v135, v135
  v_add_f32 v132, v132, v2
  v_add_f32 v133, v133, v2
  v_add_f32 v134, v134, v2
  v_add_f32 v135, v135, v2
  v_rcp_f32 v132, v132
  v_rcp_f32 v133, v133
  v_rcp_f32 v134, v134
  v_rcp_f32 v135, v135
  v_mul_f32 v132, v132, v56
  v_mul_f32 v133, v133, v57
  v_mul_f32 v134, v134, v58
  v_mul_f32 v135, v135, v59
  v_cvt_pk_bf16_f32 v142, v132, v133
  v_cvt_pk_bf16_f32 v143, v134, v135
  buffer_store_dwordx4 v[140:143], v222, s[60:63], s37 offen offset:1024 sc1
  s_waitcnt lgkmcnt(3)
  v_mfma_f32_32x32x16_bf16 v[44:59], a[128:131], v[96:99], 0
  ds_read_b128 v[124:127], v222 offset:7168
  v_mfma_f32_32x32x16_bf16 v[44:59], a[132:135], v[100:103], v[44:59]
  ds_read_b128 v[96:99], v222 offset:8192
  v_mfma_f32_32x32x16_bf16 v[44:59], a[136:139], v[104:107], v[44:59]
  ds_read_b128 v[100:103], v222 offset:9216
  buffer_load_dwordx4 v[156:159], v222, s[60:63], s68 offen offset:2048
  v_mul_f32 v128, v80, v80
  v_mul_f32 v129, v81, v81
  v_mul_f32 v130, v82, v82
  v_mul_f32 v131, v83, v83
  v_fma_f32 v128, v128, v179, v177
  v_mfma_f32_32x32x16_bf16 v[44:59], a[140:143], v[108:111], v[44:59]
  ds_read_b128 v[104:107], v222 offset:10240
  v_fma_f32 v129, v129, v179, v177
  v_fma_f32 v130, v130, v179, v177
  v_fma_f32 v131, v131, v179, v177
  v_fma_f32 v128, v128, v80, v213
  v_fma_f32 v129, v129, v81, v213
  v_fma_f32 v130, v130, v82, v213
  v_fma_f32 v131, v131, v83, v213
  s_waitcnt lgkmcnt(3)
  v_mfma_f32_32x32x16_bf16 v[44:59], a[144:147], v[112:115], v[44:59]
  ds_read_b128 v[108:111], v222 offset:11264
  buffer_load_dwordx4 v[160:163], v222, s[60:63], s68 offen offset:3072
  v_exp_f32 v128, v128
  v_mfma_f32_32x32x16_bf16 v[44:59], a[148:151], v[116:119], v[44:59]
  ds_read_b128 v[112:115], v222 offset:12288
  s_add_u32 s68, s69, 28672
  v_exp_f32 v129, v129
  v_exp_f32 v130, v130
  v_exp_f32 v131, v131
  v_mfma_f32_32x32x16_bf16 v[44:59], a[152:155], v[120:123], v[44:59]
  ds_read_b128 v[116:119], v222 offset:13312
  buffer_load_dwordx4 a[0:3], v222, s[60:63], s68 offen offset:0
  v_add_f32 v128, v128, v3
  v_add_f32 v129, v129, v3
  v_add_f32 v130, v130, v3
  v_add_f32 v131, v131, v3
  v_mfma_f32_32x32x16_bf16 v[44:59], a[156:159], v[124:127], v[44:59]
  ds_read_b128 v[120:123], v222 offset:14336
  v_rcp_f32 v128, v128
  v_rcp_f32 v129, v129
  v_rcp_f32 v130, v130
  s_waitcnt lgkmcnt(3)
  v_mfma_f32_32x32x16_bf16 v[44:59], a[160:163], v[96:99], v[44:59]
  ds_read_b128 v[124:127], v222 offset:15360
  buffer_load_dwordx4 a[4:7], v222, s[60:63], s68 offen offset:1024
  v_rcp_f32 v131, v131
  v_mul_f32 v128, v128, v80
  v_mul_f32 v129, v129, v81
  v_mfma_f32_32x32x16_bf16 v[44:59], a[164:167], v[100:103], v[44:59]
  ds_read_b128 v[96:99], v222 offset:16384
  buffer_load_dwordx4 a[8:11], v222, s[60:63], s68 offen offset:2048
  v_mul_f32 v130, v130, v82
  v_mul_f32 v131, v131, v83
  v_cvt_pk_bf16_f32 v136, v128, v129
  v_cvt_pk_bf16_f32 v137, v130, v131
  v_mul_f32 v132, v84, v84
  v_mfma_f32_32x32x16_bf16 v[44:59], a[168:171], v[104:107], v[44:59]
  ds_read_b128 v[100:103], v222 offset:17408
  v_mul_f32 v133, v85, v85
  v_mul_f32 v134, v86, v86
  v_mul_f32 v135, v87, v87
  v_fma_f32 v132, v132, v179, v177
  v_fma_f32 v133, v133, v179, v177
  v_fma_f32 v134, v134, v179, v177
  v_mfma_f32_32x32x16_bf16 v[44:59], a[172:175], v[108:111], v[44:59]
  ds_read_b128 v[104:107], v222 offset:18432
  buffer_load_dwordx4 a[12:15], v222, s[60:63], s68 offen offset:3072
  v_fma_f32 v135, v135, v179, v177
  v_fma_f32 v132, v132, v84, v213
  v_fma_f32 v133, v133, v85, v213
  v_fma_f32 v134, v134, v86, v213
  v_fma_f32 v135, v135, v87, v213
  s_waitcnt lgkmcnt(3)
  v_mfma_f32_32x32x16_bf16 v[44:59], a[176:179], v[112:115], v[44:59]
  ds_read_b128 v[108:111], v222 offset:19456
  s_add_u32 s68, s69, 36864
  v_exp_f32 v132, v132
  v_exp_f32 v133, v133
  v_mfma_f32_32x32x16_bf16 v[44:59], a[180:183], v[116:119], v[44:59]
  ds_read_b128 v[112:115], v222 offset:20480
  buffer_load_dwordx4 a[16:19], v222, s[60:63], s68 offen offset:0
  v_exp_f32 v134, v134
  v_exp_f32 v135, v135
  v_add_f32 v132, v132, v3
  v_mfma_f32_32x32x16_bf16 v[44:59], a[184:187], v[120:123], v[44:59]
  ds_read_b128 v[116:119], v222 offset:21504
  buffer_load_dwordx4 a[20:23], v222, s[60:63], s68 offen offset:1024
  v_add_f32 v133, v133, v3
  v_add_f32 v134, v134, v3
  v_add_f32 v135, v135, v3
  v_mfma_f32_32x32x16_bf16 v[44:59], a[188:191], v[124:127], v[44:59]
  ds_read_b128 v[120:123], v222 offset:22528
  v_rcp_f32 v132, v132
  v_rcp_f32 v133, v133
  v_rcp_f32 v134, v134
  s_waitcnt lgkmcnt(3)
  v_mfma_f32_32x32x16_bf16 v[44:59], a[192:195], v[96:99], v[44:59]
  ds_read_b128 v[124:127], v222 offset:23552
  buffer_load_dwordx4 a[24:27], v222, s[60:63], s68 offen offset:2048
  v_rcp_f32 v135, v135
  v_mul_f32 v132, v132, v84
  v_mul_f32 v133, v133, v85
  v_mfma_f32_32x32x16_bf16 v[44:59], a[196:199], v[100:103], v[44:59]
  ds_read_b128 v[96:99], v222 offset:24576
  v_mul_f32 v134, v134, v86
  v_mul_f32 v135, v135, v87
  v_cvt_pk_bf16_f32 v138, v132, v133
  v_cvt_pk_bf16_f32 v139, v134, v135
  s_add_u32 s37, s82, 114688
  v_mfma_f32_32x32x16_bf16 v[44:59], a[200:203], v[104:107], v[44:59]
  ds_read_b128 v[100:103], v222 offset:25600
  s_waitcnt vmcnt(9)
  s_barrier
  s_add_u32 s72, s78, 0
  buffer_store_dwordx2 v[244:245], v243, s[60:63], s72 offen sc1
  v_mfma_f32_32x32x16_bf16 v[44:59], a[204:207], v[108:111], v[44:59]
  ds_read_b128 v[104:107], v222 offset:26624
  buffer_load_dwordx4 a[28:31], v222, s[60:63], s68 offen offset:3072
  buffer_store_dwordx4 v[136:139], v222, s[60:63], s37 offen offset:0 sc1
  v_mul_f32 v128, v88, v88
  s_waitcnt lgkmcnt(3)
  v_mfma_f32_32x32x16_bf16 v[44:59], a[208:211], v[112:115], v[44:59]
  ds_read_b128 v[108:111], v222 offset:27648
  s_add_u32 s68, s69, 45056
  v_mul_f32 v129, v89, v89
  v_mul_f32 v130, v90, v90
  v_mul_f32 v131, v91, v91
  v_fma_f32 v128, v128, v179, v177
  v_fma_f32 v129, v129, v179, v177
  v_mfma_f32_32x32x16_bf16 v[44:59], a[212:215], v[116:119], v[44:59]
  ds_read_b128 v[112:115], v222 offset:28672
  v_fma_f32 v130, v130, v179, v177
  v_fma_f32 v131, v131, v179, v177
  v_fma_f32 v128, v128, v88, v213
  v_fma_f32 v129, v129, v89, v213
  v_fma_f32 v130, v130, v90, v213
  v_fma_f32 v131, v131, v91, v213
  v_mfma_f32_32x32x16_bf16 v[44:59], a[216:219], v[120:123], v[44:59]
  ds_read_b128 v[116:119], v222 offset:29696
  buffer_load_dwordx4 a[32:35], v222, s[60:63], s68 offen offset:0
  v_exp_f32 v128, v128
  v_exp_f32 v129, v129
  v_mfma_f32_32x32x16_bf16 v[44:59], a[220:223], v[124:127], v[44:59]
  ds_read_b128 v[120:123], v222 offset:30720
  v_exp_f32 v130, v130
  v_exp_f32 v131, v131
  v_add_f32 v128, v128, v3
  v_add_f32 v129, v129, v3
  v_add_f32 v130, v130, v3
  s_waitcnt lgkmcnt(3)
  v_mfma_f32_32x32x16_bf16 v[44:59], a[224:227], v[96:99], v[44:59]
  ds_read_b128 v[124:127], v222 offset:31744
  buffer_load_dwordx4 a[36:39], v222, s[60:63], s68 offen offset:1024
  v_add_f32 v131, v131, v3
  v_rcp_f32 v128, v128
  v_mfma_f32_32x32x16_bf16 v[44:59], a[228:231], v[100:103], v[44:59]
  ds_read_b128 v[96:99], v222 offset:32768
  v_rcp_f32 v129, v129
  v_rcp_f32 v130, v130
  v_rcp_f32 v131, v131
  v_mul_f32 v128, v128, v88
  v_mfma_f32_32x32x16_bf16 v[44:59], a[232:235], v[104:107], v[44:59]
  ds_read_b128 v[100:103], v222 offset:33792
  buffer_load_dwordx4 a[40:43], v222, s[60:63], s68 offen offset:2048
  v_mul_f32 v129, v129, v89
  v_mul_f32 v130, v130, v90
  v_mul_f32 v131, v131, v91
  v_cvt_pk_bf16_f32 v140, v128, v129
  v_cvt_pk_bf16_f32 v141, v130, v131
  v_mfma_f32_32x32x16_bf16 v[44:59], a[236:239], v[108:111], v[44:59]
  ds_read_b128 v[104:107], v222 offset:34816
  buffer_load_dwordx4 a[44:47], v222, s[60:63], s68 offen offset:3072
  v_mul_f32 v132, v92, v92
  v_mul_f32 v133, v93, v93
  v_mul_f32 v134, v94, v94
  v_mul_f32 v135, v95, v95
  s_waitcnt lgkmcnt(3)
  v_mfma_f32_32x32x16_bf16 v[44:59], a[240:243], v[112:115], v[44:59]
  ds_read_b128 v[108:111], v222 offset:35840
  s_add_u32 s68, s69, 53248
  v_fma_f32 v132, v132, v179, v177
  v_fma_f32 v133, v133, v179, v177
  v_fma_f32 v134, v134, v179, v177
  v_fma_f32 v135, v135, v179, v177
  v_fma_f32 v132, v132, v92, v213
  v_mfma_f32_32x32x16_bf16 v[44:59], a[244:247], v[116:119], v[44:59]
  ds_read_b128 v[112:115], v222 offset:36864
  buffer_load_dwordx4 a[48:51], v222, s[60:63], s68 offen offset:0
  v_fma_f32 v133, v133, v93, v213
  v_fma_f32 v134, v134, v94, v213
  v_fma_f32 v135, v135, v95, v213
  v_mfma_f32_32x32x16_bf16 v[44:59], a[248:251], v[120:123], v[44:59]
  ds_read_b128 v[116:119], v222 offset:37888
  v_exp_f32 v132, v132
  v_exp_f32 v133, v133
  v_exp_f32 v134, v134
  v_mfma_f32_32x32x16_bf16 v[44:59], a[252:255], v[124:127], v[44:59]
  ds_read_b128 v[120:123], v222 offset:38912
  buffer_load_dwordx4 a[52:55], v222, s[60:63], s68 offen offset:1024
  v_mfma_f32_32x32x16_bf16 v[44:59], v[24:27], v[28:31], v[44:59]
  v_exp_f32 v135, v135
  v_add_f32 v132, v132, v3
  v_add_f32 v133, v133, v3
  v_add_f32 v134, v134, v3
  v_add_f32 v135, v135, v3
  v_rcp_f32 v132, v132
  v_rcp_f32 v133, v133
  v_rcp_f32 v134, v134
  v_rcp_f32 v135, v135
  v_mul_f32 v132, v132, v92
  v_mul_f32 v133, v133, v93
  v_mul_f32 v134, v134, v94
  v_mul_f32 v135, v135, v95
  v_cvt_pk_bf16_f32 v142, v132, v133
  v_cvt_pk_bf16_f32 v143, v134, v135
  buffer_store_dwordx4 v[140:143], v222, s[60:63], s37 offen offset:1024 sc1
  s_waitcnt lgkmcnt(3)
  s_barrier
  buffer_store_dwordx2 v[244:245], v243, s[60:63], s39 offen sc1
  v_mfma_f32_32x32x16_bf16 v[80:95], a[128:131], v[96:99], 0
  ds_read_b128 v[124:127], v222 offset:39936
  v_mfma_f32_32x32x16_bf16 v[80:95], a[132:135], v[100:103], v[80:95]
  ds_read_b128 v[96:99], v222 offset:40960
  v_mfma_f32_32x32x16_bf16 v[80:95], a[136:139], v[104:107], v[80:95]
  ds_read_b128 v[100:103], v222 offset:41984
  buffer_load_dwordx4 a[56:59], v222, s[60:63], s68 offen offset:2048
  v_mul_f32 v128, v44, v44
  v_mul_f32 v129, v45, v45
  v_mul_f32 v130, v46, v46
  v_mul_f32 v131, v47, v47
  v_fma_f32 v128, v128, v178, v176
  v_fma_f32 v129, v129, v178, v176
  v_mfma_f32_32x32x16_bf16 v[80:95], a[140:143], v[108:111], v[80:95]
  ds_read_b128 v[104:107], v222 offset:43008
  v_fma_f32 v130, v130, v178, v176
  v_fma_f32 v131, v131, v178, v176
  v_fma_f32 v128, v128, v44, v212
  v_fma_f32 v129, v129, v45, v212
  v_fma_f32 v130, v130, v46, v212
  v_fma_f32 v131, v131, v47, v212
  s_waitcnt lgkmcnt(3)
  v_mfma_f32_32x32x16_bf16 v[80:95], a[144:147], v[112:115], v[80:95]
  ds_read_b128 v[108:111], v222 offset:44032
  buffer_load_dwordx4 a[60:63], v222, s[60:63], s68 offen offset:3072
  v_exp_f32 v128, v128
  v_exp_f32 v129, v129
  v_mfma_f32_32x32x16_bf16 v[80:95], a[148:151], v[116:119], v[80:95]
  ds_read_b128 v[112:115], v222 offset:45056
  s_add_u32 m0, s71, 4096
  s_add_u32 s68, s69, 32768
  v_exp_f32 v130, v130
  v_exp_f32 v131, v131
  v_add_f32 v128, v128, v2
  v_add_f32 v129, v129, v2
  v_mfma_f32_32x32x16_bf16 v[80:95], a[152:155], v[120:123], v[80:95]
  ds_read_b128 v[116:119], v222 offset:46080
  buffer_load_dwordx4 v222, s[60:63], s68 offen offset:0 lds
  v_add_f32 v130, v130, v2
  v_add_f32 v131, v131, v2
  v_rcp_f32 v128, v128
  v_mfma_f32_32x32x16_bf16 v[80:95], a[156:159], v[124:127], v[80:95]
  ds_read_b128 v[120:123], v222 offset:47104
  buffer_load_dwordx4 v222, s[60:63], s68 offen offset:1024 lds
  v_rcp_f32 v129, v129
  v_rcp_f32 v130, v130
  v_rcp_f32 v131, v131
  s_waitcnt lgkmcnt(3)
  v_mfma_f32_32x32x16_bf16 v[80:95], a[160:163], v[96:99], v[80:95]
  ds_read_b128 v[124:127], v222 offset:48128
  v_mul_f32 v128, v128, v44
  v_mul_f32 v129, v129, v45
  v_mul_f32 v130, v130, v46
  v_mul_f32 v131, v131, v47
  v_cvt_pk_bf16_f32 v136, v128, v129
  v_cvt_pk_bf16_f32 v137, v130, v131
  v_mfma_f32_32x32x16_bf16 v[80:95], a[164:167], v[100:103], v[80:95]
  ds_read_b128 v[96:99], v222 offset:49152
  buffer_load_dwordx4 v222, s[60:63], s68 offen offset:2048 lds
  v_mul_f32 v132, v48, v48
  v_mul_f32 v133, v49, v49
  v_mul_f32 v134, v50, v50
  v_mul_f32 v135, v51, v51
  v_fma_f32 v132, v132, v178, v176
  v_mfma_f32_32x32x16_bf16 v[80:95], a[168:171], v[104:107], v[80:95]
  ds_read_b128 v[100:103], v222 offset:50176
  buffer_load_dwordx4 v222, s[60:63], s68 offen offset:3072 lds
  v_fma_f32 v133, v133, v178, v176
  v_fma_f32 v134, v134, v178, v176
  v_fma_f32 v135, v135, v178, v176
  v_fma_f32 v132, v132, v48, v212
  v_fma_f32 v133, v133, v49, v212
  v_mfma_f32_32x32x16_bf16 v[80:95], a[172:175], v[108:111], v[80:95]
  ds_read_b128 v[104:107], v222 offset:51200
  s_add_u32 m0, s71, 0
  s_add_u32 s68, s69, 40960
  v_fma_f32 v134, v134, v50, v212
  v_fma_f32 v135, v135, v51, v212
  v_exp_f32 v132, v132
  s_waitcnt lgkmcnt(3)
  v_mfma_f32_32x32x16_bf16 v[80:95], a[176:179], v[112:115], v[80:95]
  ds_read_b128 v[108:111], v222 offset:52224
  s_add_u32 s26, s79, 0
  s_buffer_load_dwordx4 s[84:87], s[60:63], s26 glc
  buffer_load_dwordx4 v222, s[60:63], s68 offen offset:0 lds
  v_mfma_f32_32x32x16_bf16 v[80:95], a[180:183], v[116:119], v[80:95]
  ds_read_b128 v[112:115], v222 offset:53248
  v_exp_f32 v133, v133
  v_exp_f32 v134, v134
  v_exp_f32 v135, v135
  v_add_f32 v132, v132, v2
  v_add_f32 v133, v133, v2
  v_mfma_f32_32x32x16_bf16 v[80:95], a[184:187], v[120:123], v[80:95]
  ds_read_b128 v[116:119], v222 offset:54272
  buffer_load_dwordx4 v222, s[60:63], s68 offen offset:1024 lds
  v_add_f32 v134, v134, v2
  v_add_f32 v135, v135, v2
  v_rcp_f32 v132, v132
  v_mfma_f32_32x32x16_bf16 v[80:95], a[188:191], v[124:127], v[80:95]
  ds_read_b128 v[120:123], v222 offset:55296
  buffer_load_dwordx4 v222, s[60:63], s68 offen offset:2048 lds
  v_rcp_f32 v133, v133
  v_rcp_f32 v134, v134
  v_rcp_f32 v135, v135
  s_waitcnt lgkmcnt(3)
  v_mfma_f32_32x32x16_bf16 v[80:95], a[192:195], v[96:99], v[80:95]
  ds_read_b128 v[124:127], v222 offset:56320
  v_mul_f32 v132, v132, v48
  v_mul_f32 v133, v133, v49
  v_mul_f32 v134, v134, v50
  v_mul_f32 v135, v135, v51
  v_cvt_pk_bf16_f32 v138, v132, v133
  v_cvt_pk_bf16_f32 v139, v134, v135
  v_mfma_f32_32x32x16_bf16 v[80:95], a[196:199], v[100:103], v[80:95]
  ds_read_b128 v[96:99], v222 offset:57344
  buffer_load_dwordx4 v222, s[60:63], s68 offen offset:3072 lds
  s_add_u32 s37, s82, 0
  buffer_store_dwordx4 v[136:139], v252, s[60:63], s37 offen offset:2048 sc1
  v_mfma_f32_32x32x16_bf16 v[80:95], a[200:203], v[104:107], v[80:95]
  ds_read_b128 v[100:103], v222 offset:58368
  s_add_u32 m0, s77, 0
  s_add_u32 s68, s69, 49152
  v_mul_f32 v128, v52, v52
  v_mul_f32 v129, v53, v53
  v_mul_f32 v130, v54, v54
  v_mul_f32 v131, v55, v55
  v_fma_f32 v128, v128, v178, v176
  v_mfma_f32_32x32x16_bf16 v[80:95], a[204:207], v[108:111], v[80:95]
  ds_read_b128 v[104:107], v222 offset:59392
  v_fma_f32 v129, v129, v178, v176
  v_fma_f32 v130, v130, v178, v176
  v_fma_f32 v131, v131, v178, v176
  v_fma_f32 v128, v128, v52, v212
  v_fma_f32 v129, v129, v53, v212
  v_fma_f32 v130, v130, v54, v212
  v_fma_f32 v131, v131, v55, v212
  s_waitcnt lgkmcnt(3)
  v_mfma_f32_32x32x16_bf16 v[80:95], a[208:211], v[112:115], v[80:95]
  ds_read_b128 v[108:111], v222 offset:60416
  s_waitcnt lgkmcnt(0)
  s_cmp_eq_u64 s[84:85], s[20:21]
  s_cselect_b64 s[84:85], s[86:87], 0
  s_cmp_eq_u64 s[84:85], s[20:21]
  s_cbranch_scc0 SF_11
SB_10:
  s_add_u32 s81, s80, 0
  buffer_load_dwordx4 a[64:67], v222, s[60:63], s81 offen offset:0
  v_mfma_f32_32x32x16_bf16 v[80:95], a[212:215], v[116:119], v[80:95]
  ds_read_b128 v[112:115], v222 offset:61440
  v_exp_f32 v128, v128
  v_exp_f32 v129, v129
  v_exp_f32 v130, v130
  v_mfma_f32_32x32x16_bf16 v[80:95], a[216:219], v[120:123], v[80:95]
  ds_read_b128 v[116:119], v222 offset:62464
  s_waitcnt vmcnt(13)
  s_barrier
  s_add_u32 s72, s78, 131072
  buffer_store_dwordx2 v[244:245], v243, s[60:63], s72 offen sc1
  v_exp_f32 v131, v131
  v_add_f32 v128, v128, v2
  v_mfma_f32_32x32x16_bf16 v[80:95], a[220:223], v[124:127], v[80:95]
  ds_read_b128 v[120:123], v222 offset:63488
  buffer_load_dwordx4 a[68:71], v222, s[60:63], s81 offen offset:1024
  v_add_f32 v129, v129, v2
  v_add_f32 v130, v130, v2
  v_add_f32 v131, v131, v2
  v_rcp_f32 v128, v128
  v_mfma_f32_32x32x16_bf16 v[80:95], a[224:227], v[96:99], v[80:95]
  ds_read_b128 v[124:127], v222 offset:64512
  v_rcp_f32 v129, v129
  v_rcp_f32 v130, v130
  v_rcp_f32 v131, v131
  v_mfma_f32_32x32x16_bf16 v[80:95], a[228:231], v[100:103], v[80:95]
  s_add_u32 s81, s80, 4096
  buffer_load_dwordx4 a[72:75], v222, s[60:63], s81 offen offset:0
  v_mul_f32 v128, v128, v52
  v_mul_f32 v129, v129, v53
  v_mul_f32 v130, v130, v54
  v_mul_f32 v131, v131, v55
  v_mfma_f32_32x32x16_bf16 v[80:95], a[232:235], v[104:107], v[80:95]
  buffer_load_dwordx4 a[76:79], v222, s[60:63], s81 offen offset:1024
  v_cvt_pk_bf16_f32 v140, v128, v129
  v_cvt_pk_bf16_f32 v141, v130, v131
  v_mul_f32 v132, v56, v56
  v_mul_f32 v133, v57, v57
  v_mul_f32 v134, v58, v58
  v_mfma_f32_32x32x16_bf16 v[80:95], a[236:239], v[108:111], v[80:95]
  v_mul_f32 v135, v59, v59
  v_fma_f32 v132, v132, v178, v176
  v_fma_f32 v133, v133, v178, v176
  v_fma_f32 v134, v134, v178, v176
  v_fma_f32 v135, v135, v178, v176
  v_fma_f32 v132, v132, v56, v212
  v_fma_f32 v133, v133, v57, v212
  s_waitcnt lgkmcnt(0)
  v_mfma_f32_32x32x16_bf16 v[80:95], a[240:243], v[112:115], v[80:95]
  s_add_u32 s81, s80, 8192
  buffer_load_dwordx4 a[80:83], v222, s[60:63], s81 offen offset:0
  v_fma_f32 v134, v134, v58, v212
  v_fma_f32 v135, v135, v59, v212
  v_mfma_f32_32x32x16_bf16 v[80:95], a[244:247], v[116:119], v[80:95]
  v_exp_f32 v132, v132
  v_exp_f32 v133, v133
  v_exp_f32 v134, v134
  v_exp_f32 v135, v135
  v_mfma_f32_32x32x16_bf16 v[80:95], a[248:251], v[120:123], v[80:95]
  buffer_load_dwordx4 a[84:87], v222, s[60:63], s81 offen offset:1024
  v_add_f32 v132, v132, v2
  v_add_f32 v133, v133, v2
  v_add_f32 v134, v134, v2
  v_add_f32 v135, v135, v2
  v_mfma_f32_32x32x16_bf16 v[80:95], a[252:255], v[124:127], v[80:95]
  s_add_u32 s81, s80, 12288
  buffer_load_dwordx4 a[88:91], v222, s[60:63], s81 offen offset:0
  v_mfma_f32_32x32x16_bf16 v[80:95], v[24:27], v[32:35], v[80:95]
  v_rcp_f32 v132, v132
  v_rcp_f32 v133, v133
  v_rcp_f32 v134, v134
  v_rcp_f32 v135, v135
  v_mul_f32 v132, v132, v56
  v_mul_f32 v133, v133, v57
  v_mul_f32 v134, v134, v58
  v_mul_f32 v135, v135, v59
  v_cvt_pk_bf16_f32 v142, v132, v133
  v_cvt_pk_bf16_f32 v143, v134, v135
  buffer_store_dwordx4 v[140:143], v252, s[60:63], s37 offen offset:3072 sc1
  s_waitcnt vmcnt(8)
  v_mfma_f32_32x32x16_bf16 v[20:35], v[4:7], a[64:67], 0
  ds_read_b128 a[128:131], v250 offset:0
  ds_read_b128 a[132:135], v250 offset:1024
  v_mul_f32 v128, v80, v80
  v_mul_f32 v129, v81, v81
  v_mul_f32 v130, v82, v82
  v_mul_f32 v131, v83, v83
  v_fma_f32 v128, v128, v179, v177
  v_fma_f32 v129, v129, v179, v177
  v_fma_f32 v130, v130, v179, v177
  v_fma_f32 v131, v131, v179, v177
  v_mfma_f32_32x32x16_bf16 v[44:59], v[8:11], a[64:67], 0
  buffer_load_dwordx4 a[92:95], v222, s[60:63], s81 offen offset:1024
  v_fma_f32 v128, v128, v80, v213
  v_fma_f32 v129, v129, v81, v213
  v_fma_f32 v130, v130, v82, v213
  v_fma_f32 v131, v131, v83, v213
  v_exp_f32 v128, v128
  s_waitcnt vmcnt(7)
  v_mfma_f32_32x32x16_bf16 v[20:35], v[12:15], a[68:71], v[20:35]
  s_add_u32 s81, s80, 14336
  buffer_load_dwordx4 a[96:99], v222, s[60:63], s81 offen offset:0
  v_exp_f32 v129, v129
  v_exp_f32 v130, v130
  v_exp_f32 v131, v131
  v_add_f32 v128, v128, v3
  v_add_f32 v129, v129, v3
  v_mfma_f32_32x32x16_bf16 v[44:59], v[16:19], a[68:71], v[44:59]
  buffer_load_dwordx4 a[100:103], v222, s[60:63], s81 offen offset:1024
  v_add_f32 v130, v130, v3
  v_add_f32 v131, v131, v3
  v_rcp_f32 v128, v128
  v_rcp_f32 v129, v129
  v_rcp_f32 v130, v130
  s_add_u32 s26, s79, 131072
  s_buffer_load_dwordx4 s[84:87], s[60:63], s26 glc
  s_waitcnt vmcnt(8)
  v_mfma_f32_32x32x16_bf16 v[20:35], v[36:39], a[72:75], v[20:35]
  s_add_u32 s81, s80, 18432
  buffer_load_dwordx4 a[104:107], v222, s[60:63], s81 offen offset:0
  v_rcp_f32 v131, v131
  v_mul_f32 v128, v128, v80
  v_mul_f32 v129, v129, v81
  v_mul_f32 v130, v130, v82
  v_mul_f32 v131, v131, v83
  v_cvt_pk_bf16_f32 v136, v128, v129
  v_mfma_f32_32x32x16_bf16 v[44:59], v[40:43], a[72:75], v[44:59]
  buffer_load_dwordx4 a[108:111], v222, s[60:63], s81 offen offset:1024
  v_cvt_pk_bf16_f32 v137, v130, v131
  v_mul_f32 v132, v84, v84
  v_mul_f32 v133, v85, v85
  v_mul_f32 v134, v86, v86
  v_mul_f32 v135, v87, v87
  v_fma_f32 v132, v132, v179, v177
  v_fma_f32 v133, v133, v179, v177
  v_fma_f32 v134, v134, v179, v177
  s_waitcnt vmcnt(9)
  v_mfma_f32_32x32x16_bf16 v[20:35], v[60:63], a[76:79], v[20:35]
  s_add_u32 s81, s80, 22528
  buffer_load_dwordx4 a[112:115], v222, s[60:63], s81 offen offset:0
  v_fma_f32 v135, v135, v179, v177
  v_fma_f32 v132, v132, v84, v213
  v_fma_f32 v133, v133, v85, v213
  v_fma_f32 v134, v134, v86, v213
  v_fma_f32 v135, v135, v87, v213
  v_exp_f32 v132, v132
  v_mfma_f32_32x32x16_bf16 v[44:59], v[64:67], a[76:79], v[44:59]
  ds_read_b128 a[136:139], v250 offset:2048
  ds_read_b128 a[140:143], v250 offset:3072
  v_exp_f32 v133, v133
  v_exp_f32 v134, v134
  v_exp_f32 v135, v135
  v_add_f32 v132, v132, v3
  v_add_f32 v133, v133, v3
  s_waitcnt vmcnt(9)
  v_mfma_f32_32x32x16_bf16 v[20:35], v[68:71], a[80:83], v[20:35]
  buffer_load_dwordx4 a[116:119], v222, s[60:63], s81 offen offset:1024
  v_add_f32 v134, v134, v3
  v_add_f32 v135, v135, v3
  v_rcp_f32 v132, v132
  v_rcp_f32 v133, v133
  v_rcp_f32 v134, v134
  v_mfma_f32_32x32x16_bf16 v[44:59], v[72:75], a[80:83], v[44:59]
  ds_read_b128 a[144:147], v249 offset:0
  ds_read_b128 a[148:151], v249 offset:1024
  v_rcp_f32 v135, v135
  v_mul_f32 v132, v132, v84
  v_mul_f32 v133, v133, v85
  v_mul_f32 v134, v134, v86
  v_mul_f32 v135, v135, v87
  v_cvt_pk_bf16_f32 v138, v132, v133
  v_cvt_pk_bf16_f32 v139, v134, v135
  s_waitcnt vmcnt(9)
  v_mfma_f32_32x32x16_bf16 v[20:35], v[76:79], a[84:87], v[20:35]
  s_add_u32 s81, s80, 26624
  buffer_load_dwordx4 a[120:123], v222, s[60:63], s81 offen offset:0
  s_add_u32 s37, s82, 114688
  buffer_store_dwordx4 v[136:139], v252, s[60:63], s37 offen offset:2048 sc1
  v_mul_f32 v128, v88, v88
  v_mul_f32 v129, v89, v89
  v_mfma_f32_32x32x16_bf16 v[44:59], v[144:147], a[84:87], v[44:59]
  ds_read_b128 a[152:155], v249 offset:2048
  ds_read_b128 a[156:159], v249 offset:3072
  v_mul_f32 v130, v90, v90
  v_mul_f32 v131, v91, v91
  v_fma_f32 v128, v128, v179, v177
  v_fma_f32 v129, v129, v179, v177
  v_fma_f32 v130, v130, v179, v177
  v_fma_f32 v131, v131, v179, v177
  v_fma_f32 v128, v128, v88, v213
  v_fma_f32 v129, v129, v89, v213
  s_waitcnt vmcnt(10)
  v_mfma_f32_32x32x16_bf16 v[20:35], v[148:151], a[88:91], v[20:35]
  buffer_load_dwordx4 a[124:127], v222, s[60:63], s81 offen offset:1024
  v_fma_f32 v130, v130, v90, v213
  v_fma_f32 v131, v131, v91, v213
  v_exp_f32 v128, v128
  v_exp_f32 v129, v129
  v_exp_f32 v130, v130
  v_mfma_f32_32x32x16_bf16 v[44:59], v[152:155], a[88:91], v[44:59]
  ds_read_b128 a[160:163], v248 offset:0
  ds_read_b128 a[164:167], v248 offset:1024
  v_exp_f32 v131, v131
  v_add_f32 v128, v128, v3
  v_add_f32 v129, v129, v3
  v_add_f32 v130, v130, v3
  v_add_f32 v131, v131, v3
  v_rcp_f32 v128, v128
  s_waitcnt vmcnt(9)
  v_mfma_f32_32x32x16_bf16 v[20:35], v[156:159], a[92:95], v[20:35]
  buffer_load_dwordx4 v222, s[60:63], s68 offen offset:0 lds
  v_rcp_f32 v129, v129
  v_rcp_f32 v130, v130
  v_rcp_f32 v131, v131
  v_mul_f32 v128, v128, v88
  v_mul_f32 v129, v129, v89
  v_mfma_f32_32x32x16_bf16 v[44:59], v[160:163], a[92:95], v[44:59]
  ds_read_b128 a[168:171], v248 offset:2048
  ds_read_b128 a[172:175], v248 offset:3072
  v_mul_f32 v130, v130, v90
  v_mul_f32 v131, v131, v91
  v_cvt_pk_bf16_f32 v140, v128, v129
  v_cvt_pk_bf16_f32 v141, v130, v131
  v_mul_f32 v132, v92, v92
  v_mul_f32 v133, v93, v93
  v_mul_f32 v134, v94, v94
  v_mul_f32 v135, v95, v95
  s_waitcnt vmcnt(9)
  v_mfma_f32_32x32x16_bf16 v[20:35], a[0:3], a[96:99], v[20:35]
  buffer_load_dwordx4 v222, s[60:63], s68 offen offset:1024 lds
  v_fma_f32 v132, v132, v179, v177
  v_fma_f32 v133, v133, v179, v177
  v_fma_f32 v134, v134, v179, v177
  v_fma_f32 v135, v135, v179, v177
  v_fma_f32 v132, v132, v92, v213
  v_fma_f32 v133, v133, v93, v213
  v_fma_f32 v134, v134, v94, v213
  v_fma_f32 v135, v135, v95, v213
  v_mfma_f32_32x32x16_bf16 v[44:59], a[4:7], a[96:99], v[44:59]
  ds_read_b128 a[176:179], v241 offset:4096
  ds_read_b128 a[180:183], v241 offset:5120
  v_exp_f32 v132, v132
  v_exp_f32 v133, v133
  v_exp_f32 v134, v134
  v_exp_f32 v135, v135
  s_waitcnt lgkmcnt(0)
  s_cmp_eq_u64 s[84:85], s[20:21]
  s_cselect_b64 s[84:85], s[86:87], 0
  s_cmp_eq_u64 s[84:85], s[20:21]
  s_cbranch_scc0 SF_14
SB_13:
  s_waitcnt vmcnt(9)
  v_mfma_f32_32x32x16_bf16 v[20:35], a[8:11], a[100:103], v[20:35]
  s_add_u32 s81, s80, 0
  buffer_load_dwordx4 v[168:171], v253, s[60:63], s81 offen offset:0
  v_add_f32 v132, v132, v3
  v_add_f32 v133, v133, v3
  v_add_f32 v134, v134, v3
  v_add_f32 v135, v135, v3
  v_rcp_f32 v132, v132
  v_mfma_f32_32x32x16_bf16 v[44:59], a[12:15], a[100:103], v[44:59]
  buffer_load_dwordx4 v[172:175], v253, s[60:63], s81 offen offset:1024
  v_rcp_f32 v133, v133
  v_rcp_f32 v134, v134
  v_rcp_f32 v135, v135
  v_mul_f32 v132, v132, v92
  v_mul_f32 v133, v133, v93
  s_barrier
  s_add_u32 s72, s78, 262144
  buffer_store_dwordx2 v[244:245], v243, s[60:63], s72 offen sc1
  s_waitcnt vmcnt(11)
  v_mfma_f32_32x32x16_bf16 v[20:35], a[16:19], a[104:107], v[20:35]
  ds_read_b128 a[184:187], v241 offset:6144
  ds_read_b128 a[188:191], v241 offset:7168
  v_mul_f32 v134, v134, v94
  v_mul_f32 v135, v135, v95
  v_cvt_pk_bf16_f32 v142, v132, v133
  v_cvt_pk_bf16_f32 v143, v134, v135
  buffer_store_dwordx4 v[140:143], v252, s[60:63], s37 offen offset:3072 sc1
  v_mfma_f32_32x32x16_bf16 v[44:59], a[20:23], a[104:107], v[44:59]
  ds_read_b128 a[192:195], v241 offset:0
  ds_read_b128 a[196:199], v241 offset:1024
  v_lshrrev_b32 v180, 3, v255
  v_mul_u32_u24 v180, 4224, v180
  v_and_b32 v181, 7, v255
  v_lshl_add_u32 v234, v181, 4, v180
  v_add_u32 v235, 32768, v234
  s_lshl_b32 s64, s40, 2
  s_add_u32 s64, s64, s41
  s_mul_i32 s64, s64, 67584
  s_waitcnt vmcnt(11)
  v_mfma_f32_32x32x16_bf16 v[20:35], a[24:27], a[108:111], v[20:35]
  s_add_u32 s81, s80, 4096
  buffer_load_dwordx4 v[214:217], v253, s[60:63], s81 offen offset:0
  s_lshl_b32 s35, s3, 7
  s_add_u32 s64, s64, s35
  s_add_u32 s64, s64, 15728640
  s_lshl_b32 s65, s41, 11
  v_add_u32 v232, s71, v222
  v_bfe_u32 v184, v255, 2, 2
  v_lshl_add_u32 v184, v230, 2, v184
  v_lshlrev_b32 v184, 7, v184
  v_mfma_f32_32x32x16_bf16 v[44:59], a[28:31], a[108:111], v[44:59]
  buffer_load_dwordx4 v[218:221], v253, s[60:63], s81 offen offset:1024
  v_bfe_u32 v185, v255, 4, 1
  v_lshl_add_u32 v184, v185, 5, v184
  v_and_b32 v185, 3, v255
  v_lshl_add_u32 v184, v185, 3, v184
  s_lshl_b32 s36, s42, 12
  s_lshl_b32 s35, s43, 6
  s_add_u32 s36, s36, s35
  s_waitcnt vmcnt(12)
  v_mfma_f32_32x32x16_bf16 v[20:35], a[32:35], a[112:115], v[20:35]
  s_add_u32 s81, s80, 8192
  buffer_load_dwordx4 a[224:227], v253, s[60:63], s81 offen offset:0
  s_add_u32 s36, s36, 86272
  v_add_u32 v233, s36, v184
  v_lshlrev_b32 v185, 10, v229
  v_lshl_add_u32 v185, v230, 4, v185
  s_lshl_b32 s36, s3, 16
  s_lshl_b32 s35, s43, 15
  s_add_u32 s36, s36, s35
  s_lshl_b32 s35, s40, 7
  v_mfma_f32_32x32x16_bf16 v[44:59], a[36:39], a[112:115], v[44:59]
  buffer_load_dwordx4 a[228:231], v253, s[60:63], s81 offen offset:1024
  s_add_u32 s36, s36, s35
  s_lshl_b32 s35, s42, 6
  s_add_u32 s36, s36, s35
  v_add_u32 v240, s36, v185
  s_lshl_b32 s35, s42, 12
  s_xor_b32 s38, s43, 1
  s_lshl_b32 s38, s38, 15
  s_waitcnt vmcnt(13)
  v_mfma_f32_32x32x16_bf16 v[20:35], a[40:43], a[116:119], v[20:35]
  s_add_u32 s81, s80, 12288
  buffer_load_dwordx4 a[232:235], v253, s[60:63], s81 offen offset:0
  s_add_u32 s35, s35, s38
  v_add_u32 v226, s35, v222
  v_xor_b32 v227, 4096, v226
  v_mfma_f32_32x32x16_bf16 v[44:59], a[44:47], a[116:119], v[44:59]
  ds_read_b128 a[200:203], v241 offset:2048
  ds_read_b128 a[204:207], v241 offset:3072
  s_waitcnt vmcnt(13)
  v_mfma_f32_32x32x16_bf16 v[20:35], a[48:51], a[120:123], v[20:35]
  buffer_load_dwordx4 v222, s[60:63], s68 offen offset:2048 lds
  v_mfma_f32_32x32x16_bf16 v[44:59], a[52:55], a[120:123], v[44:59]
  buffer_load_dwordx4 a[236:239], v253, s[60:63], s81 offen offset:1024
  s_waitcnt vmcnt(13)
  v_mfma_f32_32x32x16_bf16 v[20:35], a[56:59], a[124:127], v[20:35]
  buffer_load_dwordx4 v222, s[60:63], s68 offen offset:3072 lds
  v_mfma_f32_32x32x16_bf16 v[44:59], a[60:63], a[124:127], v[44:59]
  s_add_u32 s81, s80, 14336
  buffer_load_dwordx4 a[240:243], v253, s[60:63], s81 offen offset:0
  s_waitcnt vmcnt(12)
  v_mfma_f32_32x32x16_bf16 v[96:111], v[4:7], v[168:171], 0
  buffer_load_dwordx4 a[244:247], v253, s[60:63], s81 offen offset:1024
  v_mfma_f32_32x32x16_bf16 v[112:127], v[8:11], v[168:171], 0
  s_add_u32 s26, s79, 262144
  s_buffer_load_dwordx4 s[84:87], s[60:63], s26 glc
  s_waitcnt vmcnt(12)
  v_mfma_f32_32x32x16_bf16 v[96:111], v[12:15], v[172:175], v[96:111]
  s_add_u32 s81, s80, 18432
  buffer_load_dwordx4 a[248:251], v253, s[60:63], s81 offen offset:0
  v_mfma_f32_32x32x16_bf16 v[112:127], v[16:19], v[172:175], v[112:127]
  s_waitcnt vmcnt(11)
  s_barrier
  s_add_u32 s72, s78, 393216
  buffer_store_dwordx2 v[244:245], v243, s[60:63], s72 offen sc1
  s_add_u32 s39, s32, 32768
  buffer_load_dwordx2 v[224:225], v246, s[60:63], s39 offen sc1
  s_waitcnt vmcnt(12)
  v_mfma_f32_32x32x16_bf16 v[96:111], v[36:39], v[214:217], v[96:111]
  v_mfma_f32_32x32x16_bf16 v[112:127], v[40:43], v[214:217], v[112:127]
  buffer_load_dwordx4 a[252:255], v253, s[60:63], s81 offen offset:1024
  s_waitcnt vmcnt(12)
  v_mfma_f32_32x32x16_bf16 v[96:111], v[60:63], v[218:221], v[96:111]
  s_add_u32 s81, s80, 22528
  buffer_load_dwordx4 a[64:67], v253, s[60:63], s81 offen offset:0
  v_mfma_f32_32x32x16_bf16 v[112:127], v[64:67], v[218:221], v[112:127]
  s_waitcnt vmcnt(12)
  v_mfma_f32_32x32x16_bf16 v[96:111], v[68:71], a[224:227], v[96:111]
  buffer_load_dwordx4 a[68:71], v253, s[60:63], s81 offen offset:1024
  v_mfma_f32_32x32x16_bf16 v[112:127], v[72:75], a[224:227], v[112:127]
  s_waitcnt vmcnt(12)
  v_mfma_f32_32x32x16_bf16 v[96:111], v[76:79], a[228:231], v[96:111]
  s_add_u32 s81, s80, 26624
  buffer_load_dwordx4 a[72:75], v253, s[60:63], s81 offen offset:0
  v_mfma_f32_32x32x16_bf16 v[112:127], v[144:147], a[228:231], v[112:127]
  s_waitcnt lgkmcnt(0)
  s_cmp_eq_u64 s[84:85], s[20:21]
  s_cselect_b64 s[84:85], s[86:87], 0
  s_cmp_eq_u64 s[84:85], s[20:21]
  s_cbranch_scc0 SF_17
SB_16:
  s_waitcnt vmcnt(12)
  v_mfma_f32_32x32x16_bf16 v[96:111], v[148:151], a[232:235], v[96:111]
  buffer_load_dwordx4 a[76:79], v253, s[60:63], s81 offen offset:1024
  v_mfma_f32_32x32x16_bf16 v[112:127], v[152:155], a[232:235], v[112:127]
  s_waitcnt vmcnt(11)
  v_mfma_f32_32x32x16_bf16 v[96:111], v[156:159], a[236:239], v[96:111]
  s_add_u32 s81, s80, 2048
  buffer_load_dwordx4 a[80:83], v222, s[60:63], s81 offen offset:0
  v_mfma_f32_32x32x16_bf16 v[112:127], v[160:163], a[236:239], v[112:127]
  s_waitcnt vmcnt(10)
  v_mfma_f32_32x32x16_bf16 v[96:111], a[0:3], a[240:243], v[96:111]
  buffer_load_dwordx4 a[84:87], v222, s[60:63], s81 offen offset:1024
  v_mfma_f32_32x32x16_bf16 v[112:127], a[4:7], a[240:243], v[112:127]
  s_waitcnt vmcnt(10)
  v_mfma_f32_32x32x16_bf16 v[96:111], a[8:11], a[244:247], v[96:111]
  s_add_u32 s81, s80, 6144
  buffer_load_dwordx4 a[88:91], v222, s[60:63], s81 offen offset:0
  v_mfma_f32_32x32x16_bf16 v[112:127], a[12:15], a[244:247], v[112:127]
  s_waitcnt vmcnt(10)
  v_mfma_f32_32x32x16_bf16 v[96:111], a[16:19], a[248:251], v[96:111]
  buffer_load_dwordx4 a[92:95], v222, s[60:63], s81 offen offset:1024
  v_mfma_f32_32x32x16_bf16 v[112:127], a[20:23], a[248:251], v[112:127]
  s_add_u32 s26, s79, 393216
  s_buffer_load_dwordx4 s[84:87], s[60:63], s26 glc
  s_waitcnt vmcnt(8)
  v_mfma_f32_32x32x16_bf16 v[96:111], a[24:27], a[252:255], v[96:111]
  s_add_u32 s81, s80, 10240
  buffer_load_dwordx4 a[96:99], v222, s[60:63], s81 offen offset:0
  v_mfma_f32_32x32x16_bf16 v[112:127], a[28:31], a[252:255], v[112:127]
  s_waitcnt vmcnt(8)
  v_mfma_f32_32x32x16_bf16 v[96:111], a[32:35], a[64:67], v[96:111]
  buffer_load_dwordx4 a[100:103], v222, s[60:63], s81 offen offset:1024
  v_mfma_f32_32x32x16_bf16 v[112:127], a[36:39], a[64:67], v[112:127]
  s_waitcnt vmcnt(8)
  v_mfma_f32_32x32x16_bf16 v[96:111], a[40:43], a[68:71], v[96:111]
  s_add_u32 s81, s80, 16384
  buffer_load_dwordx4 v[84:87], v222, s[60:63], s81 offen offset:0
  v_mfma_f32_32x32x16_bf16 v[112:127], a[44:47], a[68:71], v[112:127]
  ds_read_b128 a[208:211], v242 offset:0
  ds_read_b128 a[212:215], v242 offset:1024
  ds_read_b128 a[216:219], v242 offset:2048
  ds_read_b128 a[220:223], v242 offset:3072
  s_waitcnt vmcnt(8)
  v_mfma_f32_32x32x16_bf16 v[96:111], a[48:51], a[72:75], v[96:111]
  buffer_load_dwordx4 v[88:91], v222, s[60:63], s81 offen offset:1024
  v_mfma_f32_32x32x16_bf16 v[112:127], a[52:55], a[72:75], v[112:127]
  s_waitcnt vmcnt(8)
  v_mfma_f32_32x32x16_bf16 v[96:111], a[56:59], a[76:79], v[96:111]
  s_add_u32 s81, s80, 20480
  buffer_load_dwordx4 v[92:95], v222, s[60:63], s81 offen offset:0
  v_mfma_f32_32x32x16_bf16 v[112:127], a[60:63], a[76:79], v[112:127]
  s_waitcnt lgkmcnt(0)
  s_cmp_eq_u64 s[84:85], s[20:21]
  s_cselect_b64 s[84:85], s[86:87], 0
  s_cmp_eq_u64 s[84:85], s[20:21]
  s_cbranch_scc0 SF_20
SB_19:
  s_waitcnt vmcnt(8)
  v_mfma_f32_32x32x16_bf16 v[20:35], a[128:131], a[80:83], v[20:35]
  buffer_load_dwordx4 v[128:131], v222, s[60:63], s81 offen offset:1024
  v_mfma_f32_32x32x16_bf16 v[44:59], a[132:135], a[80:83], v[44:59]
  s_waitcnt vmcnt(8)
  v_mfma_f32_32x32x16_bf16 v[20:35], a[136:139], a[84:87], v[20:35]
  s_add_u32 s81, s80, 24576
  buffer_load_dwordx4 v[132:135], v222, s[60:63], s81 offen offset:0
  v_mfma_f32_32x32x16_bf16 v[44:59], a[140:143], a[84:87], v[44:59]
  s_waitcnt vmcnt(8)
  v_mfma_f32_32x32x16_bf16 v[20:35], a[144:147], a[88:91], v[20:35]
  buffer_load_dwordx4 v[136:139], v222, s[60:63], s81 offen offset:1024
  v_mfma_f32_32x32x16_bf16 v[44:59], a[148:151], a[88:91], v[44:59]
  s_waitcnt vmcnt(8)
  v_mfma_f32_32x32x16_bf16 v[20:35], a[152:155], a[92:95], v[20:35]
  s_add_u32 s81, s80, 2048
  buffer_load_dwordx4 v[140:143], v253, s[60:63], s81 offen offset:0
  v_mfma_f32_32x32x16_bf16 v[44:59], a[156:159], a[92:95], v[44:59]
  s_waitcnt vmcnt(8)
  v_mfma_f32_32x32x16_bf16 v[20:35], a[160:163], a[96:99], v[20:35]
  buffer_load_dwordx4 v[164:167], v253, s[60:63], s81 offen offset:1024
  v_mfma_f32_32x32x16_bf16 v[44:59], a[164:167], a[96:99], v[44:59]
  s_waitcnt vmcnt(8)
  v_mfma_f32_32x32x16_bf16 v[20:35], a[168:171], a[100:103], v[20:35]
  s_add_u32 s81, s80, 6144
  buffer_load_dwordx4 v[176:179], v253, s[60:63], s81 offen offset:0
  v_mfma_f32_32x32x16_bf16 v[44:59], a[172:175], a[100:103], v[44:59]
  s_waitcnt vmcnt(8)
  v_mfma_f32_32x32x16_bf16 v[20:35], a[176:179], v[84:87], v[20:35]
  buffer_load_dwordx4 a[104:107], v253, s[60:63], s81 offen offset:1024
  v_mfma_f32_32x32x16_bf16 v[44:59], a[180:183], v[84:87], v[44:59]
  s_waitcnt vmcnt(8)
  v_mfma_f32_32x32x16_bf16 v[20:35], a[184:187], v[88:91], v[20:35]
  s_add_u32 s81, s80, 10240
  buffer_load_dwordx4 a[108:111], v253, s[60:63], s81 offen offset:0
  v_mfma_f32_32x32x16_bf16 v[44:59], a[188:191], v[88:91], v[44:59]
  v_cmp_ne_u64 vcc, s[20:21], v[224:225]
  s_nop 4
  s_cbranch_vccz PK_22
  s_mov_b32 s25, 0
PL_23:
  buffer_load_dwordx2 v[224:225], v246, s[60:63], s39 offen sc1
  s_add_u32 s25, s25, 1
  s_waitcnt vmcnt(0)
  v_cmp_ne_u64 vcc, s[20:21], v[224:225]
  s_cmp_gt_u32 s25, 0x40000
  s_cbranch_scc1 PK_22
  s_nop 2
  s_cbranch_vccnz PL_23
PK_22:
  s_waitcnt vmcnt(8)
  v_mfma_f32_32x32x16_bf16 v[20:35], a[192:195], v[92:95], v[20:35]
  s_add_u32 m0, s65, 86272
  s_nop 0
  buffer_load_dwordx4 v234, s[60:63], s64 offen lds
  buffer_load_dwordx4 v235, s[60:63], s64 offen offset:1024 lds
  v_mfma_f32_32x32x16_bf16 v[44:59], a[196:199], v[92:95], v[44:59]
  buffer_load_dwordx4 a[112:115], v253, s[60:63], s81 offen offset:1024
  s_waitcnt vmcnt(10)
  v_mfma_f32_32x32x16_bf16 v[20:35], a[200:203], v[128:131], v[20:35]
  s_add_u32 s81, s80, 16384
  buffer_load_dwordx4 a[116:119], v253, s[60:63], s81 offen offset:0
  v_lshlrev_b32 v2, 16, v204
  v_and_b32 v3, 0xffff0000, v204
  v_lshlrev_b32 v4, 16, v205
  v_and_b32 v5, 0xffff0000, v205
  v_lshlrev_b32 v6, 16, v206
  v_and_b32 v7, 0xffff0000, v206
  v_lshlrev_b32 v8, 16, v207
  v_and_b32 v9, 0xffff0000, v207
  v_mfma_f32_32x32x16_bf16 v[44:59], a[204:207], v[128:131], v[44:59]
  v_lshlrev_b32 v10, 16, v208
  v_and_b32 v11, 0xffff0000, v208
  v_lshlrev_b32 v12, 16, v209
  v_and_b32 v13, 0xffff0000, v209
  v_lshlrev_b32 v14, 16, v210
  v_and_b32 v15, 0xffff0000, v210
  v_lshlrev_b32 v16, 16, v211
  v_and_b32 v17, 0xffff0000, v211
  s_waitcnt vmcnt(10)
  v_mfma_f32_32x32x16_bf16 v[20:35], a[208:211], v[132:135], v[20:35]
  buffer_load_dwordx4 a[120:123], v253, s[60:63], s81 offen offset:1024
  v_mfma_f32_32x32x16_bf16 v[44:59], a[212:215], v[132:135], v[44:59]
  s_waitcnt vmcnt(10)
  v_mfma_f32_32x32x16_bf16 v[20:35], a[216:219], v[136:139], v[20:35]
  s_add_u32 s81, s80, 20480
  buffer_load_dwordx4 a[124:127], v253, s[60:63], s81 offen offset:0
  v_mfma_f32_32x32x16_bf16 v[44:59], a[220:223], v[136:139], v[44:59]
  s_waitcnt vmcnt(10)
  v_mfma_f32_32x32x16_bf16 v[96:111], a[128:131], v[140:143], v[96:111]
  buffer_load_dwordx4 v[168:171], v253, s[60:63], s81 offen offset:1024
  v_mfma_f32_32x32x16_bf16 v[112:127], a[132:135], v[140:143], v[112:127]
  s_waitcnt vmcnt(10)
  v_mfma_f32_32x32x16_bf16 v[96:111], a[136:139], v[164:167], v[96:111]
  s_add_u32 s81, s80, 24576
  buffer_load_dwordx4 v[172:175], v253, s[60:63], s81 offen offset:0
  s_nop 0
  ds_write_b128 v232, v[20:23] offset:32768
  ds_write_b128 v232, v[24:27] offset:33792
  v_mfma_f32_32x32x16_bf16 v[112:127], a[140:143], v[164:167], v[112:127]
  ds_write_b128 v232, v[28:31] offset:34816
  ds_write_b128 v232, v[32:35] offset:35840
  ds_write_b128 v232, v[44:47] offset:36864
  s_waitcnt vmcnt(10)
  v_mfma_f32_32x32x16_bf16 v[96:111], a[144:147], v[176:179], v[96:111]
  buffer_load_dwordx4 v[214:217], v253, s[60:63], s81 offen offset:1024
  ds_write_b128 v232, v[48:51] offset:37888
  ds_write_b128 v232, v[52:55] offset:38912
  v_mfma_f32_32x32x16_bf16 v[112:127], a[148:151], v[176:179], v[112:127]
  ds_write_b128 v232, v[56:59] offset:39936
  s_waitcnt vmcnt(10)
  v_mfma_f32_32x32x16_bf16 v[96:111], a[152:155], a[104:107], v[96:111]
  v_mfma_f32_32x32x16_bf16 v[112:127], a[156:159], a[104:107], v[112:127]
  s_waitcnt vmcnt(9)
  v_mfma_f32_32x32x16_bf16 v[96:111], a[160:163], a[108:111], v[96:111]
  v_mfma_f32_32x32x16_bf16 v[112:127], a[164:167], a[108:111], v[112:127]
  s_waitcnt vmcnt(6)
  v_mfma_f32_32x32x16_bf16 v[96:111], a[168:171], a[112:115], v[96:111]
  v_mfma_f32_32x32x16_bf16 v[112:127], a[172:175], a[112:115], v[112:127]
  s_waitcnt vmcnt(5)
  v_mfma_f32_32x32x16_bf16 v[96:111], a[176:179], a[116:119], v[96:111]
  v_mfma_f32_32x32x16_bf16 v[112:127], a[180:183], a[116:119], v[112:127]
  s_waitcnt vmcnt(4)
  v_mfma_f32_32x32x16_bf16 v[96:111], a[184:187], a[120:123], v[96:111]
  v_mfma_f32_32x32x16_bf16 v[112:127], a[188:191], a[120:123], v[112:127]
  s_waitcnt vmcnt(3)
  v_mfma_f32_32x32x16_bf16 v[96:111], a[192:195], a[124:127], v[96:111]
  v_mfma_f32_32x32x16_bf16 v[112:127], a[196:199], a[124:127], v[112:127]
  s_waitcnt vmcnt(2)
  v_mfma_f32_32x32x16_bf16 v[96:111], a[200:203], v[168:171], v[96:111]
  v_mfma_f32_32x32x16_bf16 v[112:127], a[204:207], v[168:171], v[112:127]
  s_waitcnt vmcnt(1)
  v_mfma_f32_32x32x16_bf16 v[96:111], a[208:211], v[172:175], v[96:111]
  v_mfma_f32_32x32x16_bf16 v[112:127], a[212:215], v[172:175], v[112:127]
  s_waitcnt vmcnt(0)
  v_mfma_f32_32x32x16_bf16 v[96:111], a[216:219], v[214:217], v[96:111]
  v_mfma_f32_32x32x16_bf16 v[112:127], a[220:223], v[214:217], v[112:127]
  s_nop 10
  ds_write_b128 v232, v[96:99] offset:0
  ds_write_b128 v232, v[100:103] offset:1024
  ds_write_b128 v232, v[104:107] offset:2048
  ds_write_b128 v232, v[108:111] offset:3072
  ds_write_b128 v232, v[112:115] offset:4096
  ds_write_b128 v232, v[116:119] offset:5120
  ds_write_b128 v232, v[120:123] offset:6144
  ds_write_b128 v232, v[124:127] offset:7168
  s_mov_b32 s84, 0xbfb8aa3b
  s_waitcnt lgkmcnt(0)
  s_barrier
  ds_read_b128 v[20:23], v226 offset:0
  ds_read_b128 v[44:47], v227 offset:8192
  ds_read_b128 v[96:99], v226 offset:16384
  ds_read_b128 v[112:115], v227 offset:24576
  ds_read_b128 v[24:27], v226 offset:1024
  ds_read_b128 v[48:51], v227 offset:9216
  ds_read_b128 v[100:103], v226 offset:17408
  ds_read_b128 v[116:119], v227 offset:25600
  ds_read_b64_tr_b16 v[36:37], v233 offset:0
  ds_read_b64_tr_b16 v[38:39], v233 offset:1024
  ds_read_b64_tr_b16 v[40:41], v233 offset:2048
  ds_read_b64_tr_b16 v[42:43], v233 offset:3072
  ds_read_b128 v[28:31], v226 offset:2048
  ds_read_b128 v[52:55], v227 offset:10240
  ds_read_b128 v[104:107], v226 offset:18432
  ds_read_b128 v[120:123], v227 offset:26624
  ds_read_b128 v[32:35], v226 offset:3072
  ds_read_b128 v[56:59], v227 offset:11264
  ds_read_b128 v[108:111], v226 offset:19456
  ds_read_b128 v[124:127], v227 offset:27648
  s_waitcnt lgkmcnt(15)
  v_pk_add_f32 v[20:21], v[20:21], v[44:45]
  v_pk_add_f32 v[96:97], v[96:97], v[112:113]
  v_pk_add_f32 v[22:23], v[22:23], v[46:47]
  v_pk_add_f32 v[98:99], v[98:99], v[114:115]
  s_waitcnt lgkmcnt(14)
  v_pk_add_f32 v[24:25], v[24:25], v[48:49]
  s_waitcnt lgkmcnt(12)
  v_pk_add_f32 v[100:101], v[100:101], v[116:117]
  v_pk_add_f32 v[26:27], v[26:27], v[50:51]
  v_pk_add_f32 v[102:103], v[102:103], v[118:119]
  v_pk_add_f32 v[188:189], v[188:189], v[20:21]
  v_pk_add_f32 v[190:191], v[190:191], v[22:23]
  v_pk_add_f32 v[192:193], v[192:193], v[24:25]
  v_pk_add_f32 v[194:195], v[194:195], v[26:27]
  v_pk_add_f32 v[188:189], v[188:189], v[96:97]
  v_pk_add_f32 v[190:191], v[190:191], v[98:99]
  v_pk_add_f32 v[192:193], v[192:193], v[100:101]
  v_pk_add_f32 v[194:195], v[194:195], v[102:103]
  v_pk_mul_f32 v[20:21], v[188:189], s[84:85] op_sel_hi:[1,0]
  v_pk_mul_f32 v[22:23], v[190:191], s[84:85] op_sel_hi:[1,0]
  v_pk_mul_f32 v[24:25], v[192:193], s[84:85] op_sel_hi:[1,0]
  v_pk_mul_f32 v[26:27], v[194:195], s[84:85] op_sel_hi:[1,0]
  v_exp_f32 v20, v20
  v_exp_f32 v21, v21
  v_exp_f32 v22, v22
  v_exp_f32 v23, v23
  v_exp_f32 v24, v24
  v_exp_f32 v25, v25
  v_exp_f32 v26, v26
  v_exp_f32 v27, v27
  s_waitcnt lgkmcnt(11)
  v_lshlrev_b32 v44, 16, v36
  v_and_b32 v45, 0xffff0000, v36
  v_lshlrev_b32 v46, 16, v37
  v_and_b32 v47, 0xffff0000, v37
  s_waitcnt lgkmcnt(10)
  v_lshlrev_b32 v48, 16, v38
  v_and_b32 v49, 0xffff0000, v38
  v_lshlrev_b32 v50, 16, v39
  v_and_b32 v51, 0xffff0000, v39
  v_pk_add_f32 v[20:21], v[20:21], 1.0 op_sel_hi:[1,0]
  v_pk_add_f32 v[22:23], v[22:23], 1.0 op_sel_hi:[1,0]
  v_pk_add_f32 v[24:25], v[24:25], 1.0 op_sel_hi:[1,0]
  v_pk_add_f32 v[26:27], v[26:27], 1.0 op_sel_hi:[1,0]
  v_rcp_f32 v20, v20
  v_rcp_f32 v21, v21
  v_rcp_f32 v22, v22
  v_rcp_f32 v23, v23
  v_rcp_f32 v24, v24
  v_rcp_f32 v25, v25
  v_rcp_f32 v26, v26
  v_rcp_f32 v27, v27
  v_pk_mul_f32 v[188:189], v[188:189], v[44:45]
  v_pk_mul_f32 v[190:191], v[190:191], v[46:47]
  v_pk_mul_f32 v[192:193], v[192:193], v[48:49]
  v_pk_mul_f32 v[194:195], v[194:195], v[50:51]
  v_pk_fma_f32 v[188:189], v[188:189], v[20:21], v[2:3]
  v_pk_fma_f32 v[190:191], v[190:191], v[22:23], v[4:5]
  v_pk_fma_f32 v[192:193], v[192:193], v[24:25], v[6:7]
  v_pk_fma_f32 v[194:195], v[194:195], v[26:27], v[8:9]
  v_cvt_pk_bf16_f32 v36, v188, v189
  v_cvt_pk_bf16_f32 v37, v190, v191
  v_cvt_pk_bf16_f32 v38, v192, v193
  v_cvt_pk_bf16_f32 v39, v194, v195
  s_nop 0
  v_permlane32_swap_b32 v36, v38
  v_permlane32_swap_b32 v37, v39
  buffer_store_dwordx4 v[36:39], v240, s[16:19], 0 offen offset:0
  s_waitcnt lgkmcnt(6)
  v_pk_add_f32 v[28:29], v[28:29], v[52:53]
  s_waitcnt lgkmcnt(4)
  v_pk_add_f32 v[104:105], v[104:105], v[120:121]
  v_pk_add_f32 v[30:31], v[30:31], v[54:55]
  v_pk_add_f32 v[106:107], v[106:107], v[122:123]
  s_waitcnt lgkmcnt(2)
  v_pk_add_f32 v[32:33], v[32:33], v[56:57]
  s_waitcnt lgkmcnt(0)
  v_pk_add_f32 v[108:109], v[108:109], v[124:125]
  v_pk_add_f32 v[34:35], v[34:35], v[58:59]
  v_pk_add_f32 v[110:111], v[110:111], v[126:127]
  v_pk_add_f32 v[196:197], v[196:197], v[28:29]
  v_pk_add_f32 v[198:199], v[198:199], v[30:31]
  v_pk_add_f32 v[200:201], v[200:201], v[32:33]
  v_pk_add_f32 v[202:203], v[202:203], v[34:35]
  v_pk_add_f32 v[196:197], v[196:197], v[104:105]
  v_pk_add_f32 v[198:199], v[198:199], v[106:107]
  v_pk_add_f32 v[200:201], v[200:201], v[108:109]
  v_pk_add_f32 v[202:203], v[202:203], v[110:111]
  v_pk_mul_f32 v[28:29], v[196:197], s[84:85] op_sel_hi:[1,0]
  v_pk_mul_f32 v[30:31], v[198:199], s[84:85] op_sel_hi:[1,0]
  v_pk_mul_f32 v[32:33], v[200:201], s[84:85] op_sel_hi:[1,0]
  v_pk_mul_f32 v[34:35], v[202:203], s[84:85] op_sel_hi:[1,0]
  v_exp_f32 v28, v28
  v_exp_f32 v29, v29
  v_exp_f32 v30, v30
  v_exp_f32 v31, v31
  v_exp_f32 v32, v32
  v_exp_f32 v33, v33
  v_exp_f32 v34, v34
  v_exp_f32 v35, v35
  v_lshlrev_b32 v52, 16, v40
  v_and_b32 v53, 0xffff0000, v40
  v_lshlrev_b32 v54, 16, v41
  v_and_b32 v55, 0xffff0000, v41
  v_lshlrev_b32 v56, 16, v42
  v_and_b32 v57, 0xffff0000, v42
  v_lshlrev_b32 v58, 16, v43
  v_and_b32 v59, 0xffff0000, v43
  v_pk_add_f32 v[28:29], v[28:29], 1.0 op_sel_hi:[1,0]
  v_pk_add_f32 v[30:31], v[30:31], 1.0 op_sel_hi:[1,0]
  v_pk_add_f32 v[32:33], v[32:33], 1.0 op_sel_hi:[1,0]
  v_pk_add_f32 v[34:35], v[34:35], 1.0 op_sel_hi:[1,0]
  v_rcp_f32 v28, v28
  v_rcp_f32 v29, v29
  v_rcp_f32 v30, v30
  v_rcp_f32 v31, v31
  v_rcp_f32 v32, v32
  v_rcp_f32 v33, v33
  v_rcp_f32 v34, v34
  v_rcp_f32 v35, v35
  v_pk_mul_f32 v[196:197], v[196:197], v[52:53]
  v_pk_mul_f32 v[198:199], v[198:199], v[54:55]
  v_pk_mul_f32 v[200:201], v[200:201], v[56:57]
  v_pk_mul_f32 v[202:203], v[202:203], v[58:59]
  v_pk_fma_f32 v[196:197], v[196:197], v[28:29], v[10:11]
  v_pk_fma_f32 v[198:199], v[198:199], v[30:31], v[12:13]
  v_pk_fma_f32 v[200:201], v[200:201], v[32:33], v[14:15]
  v_pk_fma_f32 v[202:203], v[202:203], v[34:35], v[16:17]
  v_cvt_pk_bf16_f32 v40, v196, v197
  v_cvt_pk_bf16_f32 v41, v198, v199
  v_cvt_pk_bf16_f32 v42, v200, v201
  v_cvt_pk_bf16_f32 v43, v202, v203
  s_nop 0
  v_permlane32_swap_b32 v40, v42
  v_permlane32_swap_b32 v41, v43
  buffer_store_dwordx4 v[40:43], v240, s[16:19], 0 offen offset:32
  s_waitcnt vmcnt(0)
END:
  s_endpgm
SF_11:
  s_mov_b32 s25, 0
SF_11L:
  s_buffer_load_dwordx4 s[84:87], s[60:63], s26 glc
  s_add_u32 s25, s25, 1
  s_waitcnt lgkmcnt(0)
  s_cmp_eq_u64 s[84:85], s[20:21]
  s_cselect_b64 s[84:85], s[86:87], 0
  s_cmp_eq_u64 s[84:85], s[20:21]
  s_cbranch_scc1 SB_10
  s_cmp_lt_u32 s25, 6
  s_cbranch_scc1 SF_11L
SV_12:
  buffer_load_dwordx2 v[234:235], v251, s[60:63], s26 offen sc1
  s_add_u32 s25, s25, 1
  s_waitcnt vmcnt(0)
  v_cmp_ne_u64 vcc, s[20:21], v[234:235]
  s_cmp_gt_u32 s25, 0x40000
  s_cbranch_scc1 SB_10
  s_nop 4
  s_cbranch_vccnz SV_12
  s_branch SB_10
SF_14:
  s_mov_b32 s25, 0
SF_14L:
  s_buffer_load_dwordx4 s[84:87], s[60:63], s26 glc
  s_add_u32 s25, s25, 1
  s_waitcnt lgkmcnt(0)
  s_cmp_eq_u64 s[84:85], s[20:21]
  s_cselect_b64 s[84:85], s[86:87], 0
  s_cmp_eq_u64 s[84:85], s[20:21]
  s_cbranch_scc1 SB_13
  s_cmp_lt_u32 s25, 6
  s_cbranch_scc1 SF_14L
SV_15:
  buffer_load_dwordx2 v[224:225], v251, s[60:63], s26 offen sc1
  s_add_u32 s25, s25, 1
  s_waitcnt vmcnt(0)
  v_cmp_ne_u64 vcc, s[20:21], v[224:225]
  s_cmp_gt_u32 s25, 0x40000
  s_cbranch_scc1 SB_13
  s_nop 4
  s_cbranch_vccnz SV_15
  s_branch SB_13
SF_17:
  s_mov_b32 s25, 0
SF_17L:
  s_buffer_load_dwordx4 s[84:87], s[60:63], s26 glc
  s_add_u32 s25, s25, 1
  s_waitcnt lgkmcnt(0)
  s_cmp_eq_u64 s[84:85], s[20:21]
  s_cselect_b64 s[84:85], s[86:87], 0
  s_cmp_eq_u64 s[84:85], s[20:21]
  s_cbranch_scc1 SB_16
  s_cmp_lt_u32 s25, 6
  s_cbranch_scc1 SF_17L
SV_18:
  buffer_load_dwordx2 v[212:213], v251, s[60:63], s26 offen sc1
  s_add_u32 s25, s25, 1
  s_waitcnt vmcnt(0)
  v_cmp_ne_u64 vcc, s[20:21], v[212:213]
  s_cmp_gt_u32 s25, 0x40000
  s_cbranch_scc1 SB_16
  s_nop 4
  s_cbranch_vccnz SV_18
  s_branch SB_16
SF_20:
  s_mov_b32 s25, 0
SF_20L:
  s_buffer_load_dwordx4 s[84:87], s[60:63], s26 glc
  s_add_u32 s25, s25, 1
  s_waitcnt lgkmcnt(0)
  s_cmp_eq_u64 s[84:85], s[20:21]
  s_cselect_b64 s[84:85], s[86:87], 0
  s_cmp_eq_u64 s[84:85], s[20:21]
  s_cbranch_scc1 SB_19
  s_cmp_lt_u32 s25, 6
  s_cbranch_scc1 SF_20L
SV_21:
  buffer_load_dwordx2 v[212:213], v251, s[60:63], s26 offen sc1
  s_add_u32 s25, s25, 1
  s_waitcnt vmcnt(0)
  v_cmp_ne_u64 vcc, s[20:21], v[212:213]
  s_cmp_gt_u32 s25, 0x40000
  s_cbranch_scc1 SB_19
  s_nop 4
  s_cbranch_vccnz SV_21
  s_branch SB_19
.section .rodata,"a"
.p2align 6
.amdhsa_kernel recurrent_scan__ssm_conv_s4d__mixer_s_mlp__prompt_kernel
  .amdhsa_next_free_vgpr 512
  .amdhsa_next_free_sgpr 102
  .amdhsa_accum_offset 256
  .amdhsa_group_segment_fixed_size 0
  .amdhsa_kernarg_size 120
  .amdhsa_user_sgpr_count 2
  .amdhsa_user_sgpr_kernarg_segment_ptr 1
  .amdhsa_system_sgpr_workgroup_id_x 1
.end_amdhsa_kernel
```
